```python
import torch

def _softmax(x, axis=-1):
    return torch.softmax(x, dim=axis)
def _gelu(x):
    return torch.nn.functional.gelu(x, approximate="tanh")
def _silu(x):
    return torch.nn.functional.silu(x)
def _sigmoid(x):
    return torch.sigmoid(x)
def _layernorm(x, axis=-1, eps=1e-5):
    m = x.mean(dim=axis, keepdim=True)
    v = x.var(dim=axis, keepdim=True, unbiased=False)
    return (x - m) / torch.sqrt(v + eps)
def _scatter_add(tgt, idx, src, axis=0):
    return tgt.clone().index_add_(axis, idx, src)
def _segment_sum(src, seg, n):
    out = torch.zeros((n,) + src.shape[1:], dtype=src.dtype)
    return out.index_add_(0, seg, src)
def _pad(x, pw):
    flat = tuple(v for pair in reversed(pw) for v in pair)
    return torch.nn.functional.pad(x, flat)

kernel_name = 'sequential_preLN__sliding_block__dense_activation_squared_relu__prompt'

def setup_inputs():

    _w = (lambda a: (lambda t: t.to(torch.bfloat16) if t.is_floating_point() else t)(torch.as_tensor(a)))
    def _A_setup():
        B, S, D = 1, 2048, 448
        return {
            "x": _w((lambda *s: torch.randn(*s, dtype=torch.bfloat16) * 0.05)(B, S, D)),
            "wqkv": _w((lambda *s: torch.randn(*s, dtype=torch.bfloat16) * 0.05)(D, 3 * D)),
            "wo": _w((lambda *s: torch.randn(*s, dtype=torch.bfloat16) * 0.05)(D, D)),
        }
    _A_in = _A_setup()

    def _B_setup():
        B, S, D, F = 1, 2048, 448, 1792
        return {
            "x": _w((lambda *s: torch.randn(*s, dtype=torch.bfloat16) * 0.05)(B, S, D)),
            "w1": _w((lambda *s: torch.randn(*s, dtype=torch.bfloat16) * 0.05)(D, F)),
            "b1": _w((lambda *s: torch.randn(*s, dtype=torch.bfloat16) * 0.4)(F)),
            "w2": _w((lambda *s: torch.randn(*s, dtype=torch.bfloat16) * 0.05)(F, D)),
            "b2": _w((lambda *s: torch.randn(*s, dtype=torch.bfloat16) * 1.6)(D)),
        }
    _B_in = _B_setup()

    return {
        "A_x": _A_in["x"],
        "A_wqkv": _A_in["wqkv"],
        "A_wo": _A_in["wo"],
        "B_x": _B_in["x"],
        "B_w1": _B_in["w1"],
        "B_b1": _B_in["b1"],
        "B_w2": _B_in["w2"],
        "B_b2": _B_in["b2"],
    }

def reference(A_x, A_wqkv, A_wo, B_x, B_w1, B_b1, B_w2, B_b2):
    def _A_ref(x, wqkv, wo):
        B, S, D = x.shape
        H = 16; Dh = D // H; W = 256
        qkv = (lambda x, *d: x.permute(*d))((x @ wqkv).reshape(B, S, 3, H, Dh), 2, 0, 3, 1, 4)
        q, k, v = qkv[0], qkv[1], qkv[2]
        scores = torch.einsum("bhqd,bhkd->bhqk", q, k) * (Dh ** -0.5)
        idx = torch.arange(S)
        mask = (idx[:, None] - idx[None, :] >= 0) & (idx[:, None] - idx[None, :] < W)
        scores = torch.where(mask[None, None], scores, -1e9)
        p = _softmax(scores, axis=-1)
        o = torch.einsum("bhqk,bhkd->bhqd", p, v)
        return (lambda x, *d: x.permute(*d))(o, 0, 2, 1, 3).reshape(B, S, D) @ wo

    def _B_ref(x, w1, b1, w2, b2):
        h = torch.einsum("bsd,df->bsf", x, w1) + b1
        zero = torch.zeros_like(h)
        r = torch.where(h > zero, h, zero)
        h = r * r
        out = torch.einsum("bsf,fd->bsd", h, w2) + b2
        return out

    x = A_x
    h = x + _A_ref(_layernorm(x, axis=-1), A_wqkv, A_wo)
    h2 = h + _B_ref(_layernorm(h, axis=-1), B_w1, B_b1, B_w2, B_b2)
    return h2
```

```asm
; @launch grid=(256,1,1) block=(256,1,1) lds=163840
.amdgcn_target "amdgcn-amd-amdhsa--gfx950"
.text
.globl sequential_preLN__sliding_block__dense_activation_squared_relu__prompt_kernel
.p2align 8
.type sequential_preLN__sliding_block__dense_activation_squared_relu__prompt_kernel,@function
sequential_preLN__sliding_block__dense_activation_squared_relu__prompt_kernel:
  s_cmp_ge_u32 s2, 256
  s_cbranch_scc1 Lend
  s_load_dwordx16 s[4:19], s[0:1], 0
  s_load_dwordx4 s[20:23], s[0:1], 64
  s_load_dwordx2 s[24:25], s[0:1], 80
  s_and_b32 s68, s2, 7
  s_lshl_b32 s68, s68, 1
  s_lshr_b32 s71, s2, 7
  s_add_u32 s68, s68, s71
  s_lshr_b32 s69, s2, 3
  s_and_b32 s69, s69, 15
  v_lshrrev_b32 v2, 6, v0
  v_and_b32 v1, 63, v0
  v_readfirstlane_b32 s70, v2
  s_and_b32 s71, s2, 7
  s_lshr_b32 s72, s2, 3
  s_and_b32 s68, s71, 3
  s_lshl_b32 s68, s68, 2
  s_lshr_b32 s73, s72, 3
  s_add_u32 s68, s68, s73
  s_lshr_b32 s69, s71, 2
  s_lshl_b32 s69, s69, 3
  s_and_b32 s73, s72, 7
  s_add_u32 s69, s69, s73
  s_mov_b32 s78, 0
  s_mov_b32 s79, 7168
  s_mov_b32 s80, 14336
  s_mov_b32 s81, 21504
  s_mul_i32 s71, s69, 56
  s_and_b32 s90, s71, 15
  s_andn2_b32 s71, s71, 15
  s_mul_i32 s76, s70, 43008
  s_add_u32 s76, s76, s71
  s_mul_i32 s77, s70, 3072
  s_lshl_b32 s75, s70, 14
  s_add_u32 s75, s75, 86016
  v_add_u32 v130, 0, v1
  v_mul_u32_u24 v131, 43691, v130
  v_lshrrev_b32 v131, 19, v131
  v_mul_u32_u24 v132, 12, v131
  v_sub_u32 v132, v130, v132
  v_lshrrev_b32 v133, 2, v132
  v_and_b32 v132, 3, v132
  v_mul_u32_u24 v131, 2688, v131
  v_mul_u32_u24 v133, 896, v133
  v_lshlrev_b32 v132, 4, v132
  v_add3_u32 v118, v131, v133, v132
  v_add_u32 v130, 64, v1
  v_mul_u32_u24 v131, 43691, v130
  v_lshrrev_b32 v131, 19, v131
  v_mul_u32_u24 v132, 12, v131
  v_sub_u32 v132, v130, v132
  v_lshrrev_b32 v133, 2, v132
  v_and_b32 v132, 3, v132
  v_mul_u32_u24 v131, 2688, v131
  v_mul_u32_u24 v133, 896, v133
  v_lshlrev_b32 v132, 4, v132
  v_add3_u32 v119, v131, v133, v132
  v_add_u32 v130, 128, v1
  v_mul_u32_u24 v131, 43691, v130
  v_lshrrev_b32 v131, 19, v131
  v_mul_u32_u24 v132, 12, v131
  v_sub_u32 v132, v130, v132
  v_lshrrev_b32 v133, 2, v132
  v_and_b32 v132, 3, v132
  v_mul_u32_u24 v131, 2688, v131
  v_mul_u32_u24 v133, 896, v133
  v_lshlrev_b32 v132, 4, v132
  v_add3_u32 v120, v131, v133, v132
  s_lshl_b32 s71, s68, 7
  s_lshl_b32 s72, s70, 5
  s_add_u32 s71, s71, s72
  s_mul_i32 s71, s71, 896
  v_lshrrev_b32 v130, 3, v1
  v_mul_u32_u24 v130, 896, v130
  v_add_u32 v130, s71, v130
  v_and_b32 v131, 7, v1
  v_lshrrev_b32 v132, 4, v1
  v_xor_b32 v131, v131, v132
  v_xor_b32 v132, 4, v131
  v_lshl_add_u32 v121, v131, 4, v130
  v_lshl_add_u32 v122, v132, 4, v130
  s_waitcnt lgkmcnt(0)
  s_mov_b32 s28, s4
  s_and_b32 s29, s5, 0xffff
  s_mov_b32 s30, 1835008
  s_mov_b32 s31, 0x20000
  s_mov_b32 s32, s6
  s_and_b32 s33, s7, 0xffff
  s_mov_b32 s34, 1204224
  s_mov_b32 s35, 0x20000
  s_mov_b32 s60, s24
  s_and_b32 s61, s25, 0xffff
  s_mov_b32 s62, 268435456
  s_mov_b32 s63, 0x20000
  s_mov_b32 s64, s22
  s_and_b32 s65, s23, 0xffff
  s_mov_b32 s66, 256
  s_mov_b32 s67, 0x20000
  s_add_u32 s89, s76, 0
  s_add_u32 m0, s77, 0
  s_nop 0
  buffer_load_dwordx4 v118, s[32:35], s89 offen sc1 lds
  s_add_u32 m0, s77, 1024
  s_nop 0
  buffer_load_dwordx4 v119, s[32:35], s89 offen sc1 lds
  s_add_u32 m0, s77, 2048
  s_nop 0
  buffer_load_dwordx4 v120, s[32:35], s89 offen sc1 lds
  s_add_u32 m0, s75, 0
  s_nop 0
  buffer_load_dwordx4 v121, s[28:31], s78 offen offset:0 lds
  s_add_u32 m0, s75, 1024
  s_nop 0
  buffer_load_dwordx4 v122, s[28:31], s79 offen offset:0 lds
  s_add_u32 m0, s75, 2048
  s_nop 0
  buffer_load_dwordx4 v121, s[28:31], s80 offen offset:0 lds
  s_add_u32 m0, s75, 3072
  s_nop 0
  buffer_load_dwordx4 v122, s[28:31], s81 offen offset:0 lds
  s_add_u32 s89, s76, 172032
  s_add_u32 m0, s77, 12288
  s_nop 0
  buffer_load_dwordx4 v118, s[32:35], s89 offen sc1 lds
  s_add_u32 m0, s77, 13312
  s_nop 0
  buffer_load_dwordx4 v119, s[32:35], s89 offen sc1 lds
  s_add_u32 m0, s77, 14336
  s_nop 0
  buffer_load_dwordx4 v120, s[32:35], s89 offen sc1 lds
  s_add_u32 m0, s75, 3968
  s_nop 0
  buffer_load_dwordx4 v121, s[28:31], s78 offen offset:128 lds
  s_add_u32 m0, s75, 4992
  s_nop 0
  buffer_load_dwordx4 v122, s[28:31], s79 offen offset:128 lds
  s_add_u32 m0, s75, 6016
  s_nop 0
  buffer_load_dwordx4 v121, s[28:31], s80 offen offset:128 lds
  s_add_u32 m0, s75, 7040
  s_nop 0
  buffer_load_dwordx4 v122, s[28:31], s81 offen offset:128 lds
  s_lshr_b32 s95, s2, 3
  s_lshl_b32 s95, s95, 2
  s_add_u32 s95, s95, s70
  s_or_b32 s71, s2, s70
  s_cmp_lg_u32 s71, 0
  s_cbranch_scc1 Lep_1
  s_memrealtime s[96:97]
  s_waitcnt lgkmcnt(0)
  s_or_b32 s97, s97, 0x80000000
  v_mov_b32 v2, s96
  v_mov_b32 v3, s97
  v_mov_b32 v4, 0
  s_mov_b64 exec, 1
  buffer_store_dwordx2 v[2:3], v4, s[64:67], 0 offen sc1
  s_mov_b64 exec, -1
Lep_1:
  s_mov_b32 s36, s8
  s_and_b32 s37, s9, 0xffff
  s_mov_b32 s38, 401408
  s_mov_b32 s39, 0x20000
  s_mov_b32 s40, s12
  s_and_b32 s41, s13, 0xffff
  s_mov_b32 s42, 1605632
  s_mov_b32 s43, 0x20000
  s_mov_b32 s44, s14
  s_and_b32 s45, s15, 0xffff
  s_mov_b32 s46, 3584
  s_mov_b32 s47, 0x20000
  s_mov_b32 s48, s16
  s_and_b32 s49, s17, 0xffff
  s_mov_b32 s50, 1605632
  s_mov_b32 s51, 0x20000
  s_mov_b32 s52, s18
  s_and_b32 s53, s19, 0xffff
  s_mov_b32 s54, 896
  s_mov_b32 s55, 0x20000
  s_mov_b32 s56, s20
  s_and_b32 s57, s21, 0xffff
  s_mov_b32 s58, 1835008
  s_mov_b32 s59, 0x20000
  s_mov_b32 s6, 0
  s_mov_b32 s7, -1
  s_lshl_b32 s8, s68, 4
  s_add_u32 s8, s8, s69
  s_min_u32 s71, s69, 13
  s_and_b32 s93, s71, 1
  s_lshr_b32 s92, s71, 1
  s_lshl_b32 s91, s92, 7
  v_add_u32 v133, 0, v1
  v_mul_u32_u24 v134, 18725, v133
  v_lshrrev_b32 v134, 18, v134
  v_mul_u32_u24 v135, 14, v134
  v_sub_u32 v135, v133, v135
  v_lshl_or_b32 v224, v135, 8, v134
  v_add_u32 v133, 64, v1
  v_mul_u32_u24 v134, 18725, v133
  v_lshrrev_b32 v134, 18, v134
  v_mul_u32_u24 v135, 14, v134
  v_sub_u32 v135, v133, v135
  v_lshl_or_b32 v225, v135, 8, v134
  v_add_u32 v133, 128, v1
  v_mul_u32_u24 v134, 18725, v133
  v_lshrrev_b32 v134, 18, v134
  v_mul_u32_u24 v135, 14, v134
  v_sub_u32 v135, v133, v135
  v_lshl_or_b32 v226, v135, 8, v134
  v_add_u32 v133, 192, v1
  v_mul_u32_u24 v134, 18725, v133
  v_lshrrev_b32 v134, 18, v134
  v_mul_u32_u24 v135, 14, v134
  v_sub_u32 v135, v133, v135
  v_lshl_or_b32 v227, v135, 8, v134
  v_add_u32 v133, 256, v1
  v_mul_u32_u24 v134, 18725, v133
  v_lshrrev_b32 v134, 18, v134
  v_mul_u32_u24 v135, 14, v134
  v_sub_u32 v135, v133, v135
  v_lshl_or_b32 v228, v135, 8, v134
  v_add_u32 v133, 320, v1
  v_mul_u32_u24 v134, 18725, v133
  v_lshrrev_b32 v134, 18, v134
  v_mul_u32_u24 v135, 14, v134
  v_sub_u32 v135, v133, v135
  v_lshl_or_b32 v229, v135, 8, v134
  v_add_u32 v133, 384, v1
  v_mul_u32_u24 v134, 18725, v133
  v_lshrrev_b32 v134, 18, v134
  v_mul_u32_u24 v135, 14, v134
  v_sub_u32 v135, v133, v135
  v_lshl_or_b32 v230, v135, 8, v134
  s_mov_b32 s12, 0
  s_cmp_lg_u32 s70, 3
  s_cbranch_scc1 Lw2t_2
  s_cmp_ge_u32 s8, 224
  s_cbranch_scc1 Lw2t_2
  s_mov_b32 s12, 1
  s_lshr_b32 s10, s8, 2
  s_and_b32 s11, s8, 3
  s_mul_i32 s71, s10, 37
  s_lshr_b32 s71, s71, 8
  s_mul_i32 s72, s71, 7
  s_sub_u32 s72, s10, s72
  s_mul_i32 s71, s71, 14
  s_lshr_b32 s73, s72, 1
  s_mul_i32 s73, s73, 7
  s_and_b32 s74, s72, 1
  s_lshl_b32 s74, s74, 1
  s_add_u32 s73, s73, s74
  s_sub_u32 s74, s72, 4
  s_mul_i32 s74, s74, 7
  s_add_u32 s74, s74, 4
  s_cmp_ge_u32 s72, 4
  s_cselect_b32 s73, s74, s73
  s_cmp_eq_u32 s72, 6
  s_cselect_b32 s73, 6, s73
  s_cselect_b32 s74, 86016, 0
  s_add_u32 s73, s73, s71
  s_mul_i32 s73, s73, 14336
  s_mul_i32 s71, s11, 224
  s_add_u32 s73, s73, s71
  v_and_b32 v133, 0xff, v224
  v_lshrrev_b32 v134, 8, v224
  v_mul_u32_u24 v135, 896, v133
  v_lshl_add_u32 v135, v134, 4, v135
  v_cmp_lt_u32 vcc, 15, v133
  v_mov_b32 v136, s74
  s_nop 0
  v_cndmask_b32 v136, 0, v136, vcc
  v_add_u32 v135, v135, v136
  s_mov_b32 m0, 151552
  s_nop 0
  buffer_load_dwordx4 v135, s[48:51], s73 offen lds
  v_and_b32 v133, 0xff, v225
  v_lshrrev_b32 v134, 8, v225
  v_mul_u32_u24 v135, 896, v133
  v_lshl_add_u32 v135, v134, 4, v135
  v_cmp_lt_u32 vcc, 15, v133
  v_mov_b32 v136, s74
  s_nop 0
  v_cndmask_b32 v136, 0, v136, vcc
  v_add_u32 v135, v135, v136
  s_mov_b32 m0, 152576
  s_nop 0
  buffer_load_dwordx4 v135, s[48:51], s73 offen lds
  v_and_b32 v133, 0xff, v226
  v_lshrrev_b32 v134, 8, v226
  v_mul_u32_u24 v135, 896, v133
  v_lshl_add_u32 v135, v134, 4, v135
  v_cmp_lt_u32 vcc, 15, v133
  v_mov_b32 v136, s74
  s_nop 0
  v_cndmask_b32 v136, 0, v136, vcc
  v_add_u32 v135, v135, v136
  s_mov_b32 m0, 153600
  s_nop 0
  buffer_load_dwordx4 v135, s[48:51], s73 offen lds
  v_and_b32 v133, 0xff, v227
  v_lshrrev_b32 v134, 8, v227
  v_mul_u32_u24 v135, 896, v133
  v_lshl_add_u32 v135, v134, 4, v135
  v_cmp_lt_u32 vcc, 15, v133
  v_mov_b32 v136, s74
  s_nop 0
  v_cndmask_b32 v136, 0, v136, vcc
  v_add_u32 v135, v135, v136
  s_mov_b32 m0, 154624
  s_nop 0
  buffer_load_dwordx4 v135, s[48:51], s73 offen lds
  v_and_b32 v133, 0xff, v228
  v_lshrrev_b32 v134, 8, v228
  v_mul_u32_u24 v135, 896, v133
  v_lshl_add_u32 v135, v134, 4, v135
  v_cmp_lt_u32 vcc, 15, v133
  v_mov_b32 v136, s74
  s_nop 0
  v_cndmask_b32 v136, 0, v136, vcc
  v_add_u32 v135, v135, v136
  s_mov_b32 m0, 155648
  s_nop 0
  buffer_load_dwordx4 v135, s[48:51], s73 offen lds
  v_and_b32 v133, 0xff, v229
  v_lshrrev_b32 v134, 8, v229
  v_mul_u32_u24 v135, 896, v133
  v_lshl_add_u32 v135, v134, 4, v135
  v_cmp_lt_u32 vcc, 15, v133
  v_mov_b32 v136, s74
  s_nop 0
  v_cndmask_b32 v136, 0, v136, vcc
  v_add_u32 v135, v135, v136
  s_mov_b32 m0, 156672
  s_nop 0
  buffer_load_dwordx4 v135, s[48:51], s73 offen lds
  v_and_b32 v133, 0xff, v230
  v_lshrrev_b32 v134, 8, v230
  v_mul_u32_u24 v135, 896, v133
  v_lshl_add_u32 v135, v134, 4, v135
  v_cmp_lt_u32 vcc, 15, v133
  v_mov_b32 v136, s74
  s_nop 0
  v_cndmask_b32 v136, 0, v136, vcc
  v_add_u32 v135, v135, v136
  s_mov_b32 m0, 157696
  s_nop 0
  buffer_load_dwordx4 v135, s[48:51], s73 offen lds
Lw2t_2:
  v_and_b32 v130, 31, v1
  v_lshrrev_b32 v131, 5, v1
  v_bfe_u32 v132, v130, 1, 3
  v_xor_b32 v132, v132, v131
  v_lshlrev_b32 v133, 7, v130
  v_add_u32 v133, s75, v133
  v_xor_b32 v134, 0, v132
  v_lshl_add_u32 v123, v134, 4, v133
  v_xor_b32 v134, 2, v132
  v_lshl_add_u32 v124, v134, 4, v133
  v_xor_b32 v134, 4, v132
  v_lshl_add_u32 v125, v134, 4, v133
  v_xor_b32 v134, 6, v132
  v_lshl_add_u32 v126, v134, 4, v133
  v_bfe_u32 v132, v1, 2, 2
  v_lshl_add_u32 v132, v131, 3, v132
  v_mul_u32_u24 v132, 192, v132
  v_bfe_u32 v133, v1, 4, 1
  v_lshl_add_u32 v132, v133, 5, v132
  v_and_b32 v133, 3, v1
  v_lshl_add_u32 v132, v133, 3, v132
  v_add_u32 v127, s90, v132
  v_add_u32 v128, 61440, v127
  v_cmp_eq_u32 s[82:83], 1, v133
  v_cmp_eq_u32 s[84:85], 2, v133
  v_cmp_eq_u32 s[86:87], 3, v133
  v_mov_b32 v96, 0
  v_mov_b32 v97, 0
  v_mov_b32 v98, 0
  v_mov_b32 v99, 0
  v_mov_b32 v100, 0
  v_mov_b32 v101, 0
  v_mov_b32 v102, 0
  v_mov_b32 v103, 0
  v_mov_b32 v104, 0
  v_mov_b32 v105, 0
  v_mov_b32 v106, 0
  v_mov_b32 v107, 0
  v_mov_b32 v108, 0
  v_mov_b32 v109, 0
  v_mov_b32 v110, 0
  v_mov_b32 v111, 0
  v_mov_b32 v112, 0
  v_mov_b32 v113, 0
  v_mov_b32 v114, 0
  v_mov_b32 v115, 0
  v_mov_b32 v116, 0x3f803f80
  v_mov_b32 v117, 0x3f803f80
  s_add_u32 s89, s76, 344064
  s_add_u32 m0, s77, 24576
  s_nop 0
  buffer_load_dwordx4 v118, s[32:35], s89 offen sc1 lds
  s_add_u32 m0, s77, 25600
  s_nop 0
  buffer_load_dwordx4 v119, s[32:35], s89 offen sc1 lds
  s_add_u32 m0, s77, 26624
  s_nop 0
  buffer_load_dwordx4 v120, s[32:35], s89 offen sc1 lds
  s_add_u32 m0, s75, 7936
  s_nop 0
  buffer_load_dwordx4 v121, s[28:31], s78 offen offset:256 lds
  s_add_u32 m0, s75, 8960
  s_nop 0
  buffer_load_dwordx4 v122, s[28:31], s79 offen offset:256 lds
  s_add_u32 m0, s75, 9984
  s_nop 0
  buffer_load_dwordx4 v121, s[28:31], s80 offen offset:256 lds
  s_add_u32 m0, s75, 11008
  s_nop 0
  buffer_load_dwordx4 v122, s[28:31], s81 offen offset:256 lds
  s_add_u32 s89, s76, 516096
  s_add_u32 m0, s77, 36864
  s_nop 0
  buffer_load_dwordx4 v118, s[32:35], s89 offen sc1 lds
  s_add_u32 m0, s77, 37888
  s_nop 0
  buffer_load_dwordx4 v119, s[32:35], s89 offen sc1 lds
  s_add_u32 m0, s77, 38912
  s_nop 0
  buffer_load_dwordx4 v120, s[32:35], s89 offen sc1 lds
  v_and_b32 v132, 15, v1
  s_lshl_b32 s71, s70, 4
  v_add_u32 v132, s71, v132
  v_mul_u32_u24 v132, 192, v132
  s_add_u32 s71, s90, 120
  v_add_u32 v129, s71, v132
  v_add_u32 v234, 61440, v129
  s_waitcnt vmcnt(21)
  ds_write_b16 v129, v116 offset:0
  s_waitcnt lgkmcnt(0)
  s_barrier
  ds_read_b64_tr_b16 a[16:17], v127 offset:64
  ds_read_b64_tr_b16 a[18:19], v127 offset:832
  ds_read_b64_tr_b16 a[20:21], v127 offset:3136
  ds_read_b64_tr_b16 a[22:23], v127 offset:3904
  ds_read_b64_tr_b16 a[24:25], v127 offset:6208
  ds_read_b64_tr_b16 a[26:27], v127 offset:6976
  ds_read_b64_tr_b16 a[28:29], v127 offset:9280
  ds_read_b64_tr_b16 a[30:31], v127 offset:10048
  ds_read_b64_tr_b16 a[0:1], v127 offset:0
  ds_read_b64_tr_b16 a[2:3], v127 offset:768
  ds_read_b64_tr_b16 a[4:5], v127 offset:3072
  ds_read_b64_tr_b16 a[6:7], v127 offset:3840
  ds_read_b64_tr_b16 a[8:9], v127 offset:6144
  ds_read_b64_tr_b16 a[10:11], v127 offset:6912
  ds_read_b64_tr_b16 a[12:13], v127 offset:9216
  ds_read_b64_tr_b16 a[14:15], v127 offset:9984
  ds_read_b64_tr_b16 a[32:33], v127 offset:128
  ds_read_b64_tr_b16 a[34:35], v127 offset:896
  ds_read_b64_tr_b16 a[36:37], v127 offset:3200
  ds_read_b64_tr_b16 a[38:39], v127 offset:3968
  ds_read_b64_tr_b16 a[40:41], v127 offset:6272
  ds_read_b64_tr_b16 a[42:43], v127 offset:7040
  ds_read_b64_tr_b16 a[44:45], v127 offset:9344
  ds_read_b64_tr_b16 a[46:47], v127 offset:10112
  s_waitcnt vmcnt(17)
  ds_read_b128 v[64:67], v123 offset:0
  ds_read_b128 v[68:71], v124 offset:0
  ds_read_b128 v[72:75], v125 offset:0
  ds_read_b128 v[76:79], v126 offset:0
  s_waitcnt vmcnt(14)
  ds_write_b16 v129, v116 offset:12288
  v_lshrrev_b32 v231, 4, v1
  v_bfe_u32 v232, v1, 2, 2
  v_and_b32 v233, 3, v1
  s_waitcnt lgkmcnt(0)
  v_mfma_f32_32x32x16_bf16 v[32:47], a[16:19], v[64:67], 0
  s_add_u32 s89, s76, 688128
  s_add_u32 m0, s77, 49152
  s_nop 0
  buffer_load_dwordx4 v118, s[32:35], s89 offen sc1 lds
  s_barrier
  v_mfma_f32_32x32x16_bf16 v[16:31], a[0:3], v[64:67], 0
  ds_read_b64_tr_b16 a[64:65], v127 offset:12352
  ds_read_b64_tr_b16 a[66:67], v127 offset:13120
  ds_read_b64_tr_b16 a[68:69], v127 offset:15424
  v_mfma_f32_32x32x16_bf16 v[48:63], v[64:67], a[32:35], 0
  ds_read_b64_tr_b16 a[70:71], v127 offset:16192
  s_add_u32 m0, s77, 50176
  s_nop 0
  buffer_load_dwordx4 v119, s[32:35], s89 offen sc1 lds
  ds_read_b64_tr_b16 a[72:73], v127 offset:18496
  v_mfma_f32_32x32x16_bf16 v[32:47], a[20:23], v[68:71], v[32:47]
  ds_read_b64_tr_b16 a[74:75], v127 offset:19264
  ds_read_b64_tr_b16 a[76:77], v127 offset:21568
  ds_read_b64_tr_b16 a[78:79], v127 offset:22336
  v_mfma_f32_32x32x16_bf16 v[16:31], a[4:7], v[68:71], v[16:31]
  s_add_u32 m0, s77, 51200
  s_nop 0
  buffer_load_dwordx4 v120, s[32:35], s89 offen sc1 lds
  ds_read_b64_tr_b16 a[48:49], v127 offset:12288
  ds_read_b64_tr_b16 a[50:51], v127 offset:13056
  v_mfma_f32_32x32x16_bf16 v[48:63], v[68:71], a[36:39], v[48:63]
  ds_read_b64_tr_b16 a[52:53], v127 offset:15360
  ds_read_b64_tr_b16 a[54:55], v127 offset:16128
  s_waitcnt vmcnt(13)
  v_mfma_f32_4x4x4_16b_bf16 v[96:99], v[64:65], v[64:65], v[96:99]
  v_mfma_f32_4x4x4_16b_bf16 v[100:103], v[66:67], v[66:67], v[100:103]
  s_nop 0
  v_mfma_f32_4x4x4_16b_bf16 v[96:99], v[68:69], v[68:69], v[96:99]
  v_mfma_f32_4x4x4_16b_bf16 v[100:103], v[70:71], v[70:71], v[100:103]
  s_nop 0
  v_mfma_f32_4x4x4_16b_bf16 v[96:99], v[72:73], v[72:73], v[96:99]
  v_mfma_f32_4x4x4_16b_bf16 v[100:103], v[74:75], v[74:75], v[100:103]
  s_nop 0
  v_mfma_f32_4x4x4_16b_bf16 v[96:99], v[76:77], v[76:77], v[96:99]
  v_mfma_f32_4x4x4_16b_bf16 v[100:103], v[78:79], v[78:79], v[100:103]
  s_cmp_lg_u32 s70, 0
  s_cbranch_scc1 Lcs_3
  v_mfma_f32_4x4x4_16b_bf16 v[104:107], a[0:1], v[116:117], v[104:107]
  v_mfma_f32_4x4x4_16b_bf16 v[108:111], a[16:17], v[116:117], v[108:111]
  v_mfma_f32_4x4x4_16b_bf16 v[112:115], a[32:33], v[116:117], v[112:115]
  v_mfma_f32_4x4x4_16b_bf16 v[104:107], a[2:3], v[116:117], v[104:107]
  v_mfma_f32_4x4x4_16b_bf16 v[108:111], a[18:19], v[116:117], v[108:111]
  v_mfma_f32_4x4x4_16b_bf16 v[112:115], a[34:35], v[116:117], v[112:115]
Lcs_3:
  s_cmp_lg_u32 s70, 1
  s_cbranch_scc1 Lcs_4
  v_mfma_f32_4x4x4_16b_bf16 v[104:107], a[4:5], v[116:117], v[104:107]
  v_mfma_f32_4x4x4_16b_bf16 v[108:111], a[20:21], v[116:117], v[108:111]
  v_mfma_f32_4x4x4_16b_bf16 v[112:115], a[36:37], v[116:117], v[112:115]
  v_mfma_f32_4x4x4_16b_bf16 v[104:107], a[6:7], v[116:117], v[104:107]
  v_mfma_f32_4x4x4_16b_bf16 v[108:111], a[22:23], v[116:117], v[108:111]
  v_mfma_f32_4x4x4_16b_bf16 v[112:115], a[38:39], v[116:117], v[112:115]
Lcs_4:
  s_cmp_lg_u32 s70, 2
  s_cbranch_scc1 Lcs_5
  v_mfma_f32_4x4x4_16b_bf16 v[104:107], a[8:9], v[116:117], v[104:107]
  v_mfma_f32_4x4x4_16b_bf16 v[108:111], a[24:25], v[116:117], v[108:111]
  v_mfma_f32_4x4x4_16b_bf16 v[112:115], a[40:41], v[116:117], v[112:115]
  v_mfma_f32_4x4x4_16b_bf16 v[104:107], a[10:11], v[116:117], v[104:107]
  v_mfma_f32_4x4x4_16b_bf16 v[108:111], a[26:27], v[116:117], v[108:111]
  v_mfma_f32_4x4x4_16b_bf16 v[112:115], a[42:43], v[116:117], v[112:115]
Lcs_5:
  s_cmp_lg_u32 s70, 3
  s_cbranch_scc1 Lcs_6
  v_mfma_f32_4x4x4_16b_bf16 v[104:107], a[12:13], v[116:117], v[104:107]
  v_mfma_f32_4x4x4_16b_bf16 v[108:111], a[28:29], v[116:117], v[108:111]
  v_mfma_f32_4x4x4_16b_bf16 v[112:115], a[44:45], v[116:117], v[112:115]
  v_mfma_f32_4x4x4_16b_bf16 v[104:107], a[14:15], v[116:117], v[104:107]
  v_mfma_f32_4x4x4_16b_bf16 v[108:111], a[30:31], v[116:117], v[108:111]
  v_mfma_f32_4x4x4_16b_bf16 v[112:115], a[46:47], v[116:117], v[112:115]
Lcs_6:
  s_add_u32 m0, s75, 11904
  s_nop 0
  buffer_load_dwordx4 v121, s[28:31], s78 offen offset:384 lds
  ds_read_b128 v[80:83], v123 offset:4096
  ds_read_b128 v[84:87], v124 offset:4096
  v_mfma_f32_32x32x16_bf16 v[32:47], a[24:27], v[72:75], v[32:47]
  ds_read_b128 v[88:91], v125 offset:4096
  ds_read_b128 v[92:95], v126 offset:4096
  s_add_u32 m0, s75, 12928
  s_nop 0
  buffer_load_dwordx4 v122, s[28:31], s79 offen offset:384 lds
  v_mfma_f32_32x32x16_bf16 v[16:31], a[8:11], v[72:75], v[16:31]
  ds_read_b64_tr_b16 a[56:57], v127 offset:18432
  ds_read_b64_tr_b16 a[58:59], v127 offset:19200
  ds_read_b64_tr_b16 a[60:61], v127 offset:21504
  v_mfma_f32_32x32x16_bf16 v[48:63], v[72:75], a[40:43], v[48:63]
  ds_read_b64_tr_b16 a[62:63], v127 offset:22272
  ds_read_b64_tr_b16 a[80:81], v127 offset:12416
  s_add_u32 m0, s75, 13952
  s_nop 0
  buffer_load_dwordx4 v121, s[28:31], s80 offen offset:384 lds
  v_mfma_f32_32x32x16_bf16 v[32:47], a[28:31], v[76:79], v[32:47]
  ds_read_b64_tr_b16 a[82:83], v127 offset:13184
  ds_read_b64_tr_b16 a[84:85], v127 offset:15488
  ds_read_b64_tr_b16 a[86:87], v127 offset:16256
  v_mfma_f32_32x32x16_bf16 v[16:31], a[12:15], v[76:79], v[16:31]
  ds_read_b64_tr_b16 a[88:89], v127 offset:18560
  s_add_u32 m0, s75, 14976
  s_nop 0
  buffer_load_dwordx4 v122, s[28:31], s81 offen offset:384 lds
  ds_read_b64_tr_b16 a[90:91], v127 offset:19328
  v_mfma_f32_32x32x16_bf16 v[48:63], v[76:79], a[44:47], v[48:63]
  ds_read_b64_tr_b16 a[92:93], v127 offset:21632
  ds_read_b64_tr_b16 a[94:95], v127 offset:22400
  s_waitcnt vmcnt(14)
  ds_write_b16 v129, v116 offset:24576
  s_waitcnt lgkmcnt(0)
  v_mfma_f32_32x32x16_bf16 v[32:47], a[64:67], v[80:83], v[32:47]
  s_add_u32 s89, s76, 860160
  s_add_u32 m0, s77, 61440
  s_nop 0
  buffer_load_dwordx4 v118, s[32:35], s89 offen sc1 lds
  s_barrier
  v_mfma_f32_32x32x16_bf16 v[16:31], a[48:51], v[80:83], v[16:31]
  ds_read_b64_tr_b16 a[16:17], v127 offset:24640
  ds_read_b64_tr_b16 a[18:19], v127 offset:25408
  ds_read_b64_tr_b16 a[20:21], v127 offset:27712
  v_mfma_f32_32x32x16_bf16 v[48:63], v[80:83], a[80:83], v[48:63]
  ds_read_b64_tr_b16 a[22:23], v127 offset:28480
  s_add_u32 m0, s77, 62464
  s_nop 0
  buffer_load_dwordx4 v119, s[32:35], s89 offen sc1 lds
  ds_read_b64_tr_b16 a[24:25], v127 offset:30784
  v_mfma_f32_32x32x16_bf16 v[32:47], a[68:71], v[84:87], v[32:47]
  ds_read_b64_tr_b16 a[26:27], v127 offset:31552
  ds_read_b64_tr_b16 a[28:29], v127 offset:33856
  ds_read_b64_tr_b16 a[30:31], v127 offset:34624
  v_mfma_f32_32x32x16_bf16 v[16:31], a[52:55], v[84:87], v[16:31]
  s_add_u32 m0, s77, 63488
  s_nop 0
  buffer_load_dwordx4 v120, s[32:35], s89 offen sc1 lds
  ds_read_b64_tr_b16 a[0:1], v127 offset:24576
  ds_read_b64_tr_b16 a[2:3], v127 offset:25344
  v_mfma_f32_32x32x16_bf16 v[48:63], v[84:87], a[84:87], v[48:63]
  ds_read_b64_tr_b16 a[4:5], v127 offset:27648
  ds_read_b64_tr_b16 a[6:7], v127 offset:28416
  s_waitcnt vmcnt(13)
  v_mfma_f32_4x4x4_16b_bf16 v[96:99], v[80:81], v[80:81], v[96:99]
  v_mfma_f32_4x4x4_16b_bf16 v[100:103], v[82:83], v[82:83], v[100:103]
  s_nop 0
  v_mfma_f32_4x4x4_16b_bf16 v[96:99], v[84:85], v[84:85], v[96:99]
  v_mfma_f32_4x4x4_16b_bf16 v[100:103], v[86:87], v[86:87], v[100:103]
  s_nop 0
  v_mfma_f32_4x4x4_16b_bf16 v[96:99], v[88:89], v[88:89], v[96:99]
  v_mfma_f32_4x4x4_16b_bf16 v[100:103], v[90:91], v[90:91], v[100:103]
  s_nop 0
  v_mfma_f32_4x4x4_16b_bf16 v[96:99], v[92:93], v[92:93], v[96:99]
  v_mfma_f32_4x4x4_16b_bf16 v[100:103], v[94:95], v[94:95], v[100:103]
  s_cmp_lg_u32 s70, 0
  s_cbranch_scc1 Lcs_7
  v_mfma_f32_4x4x4_16b_bf16 v[104:107], a[48:49], v[116:117], v[104:107]
  v_mfma_f32_4x4x4_16b_bf16 v[108:111], a[64:65], v[116:117], v[108:111]
  v_mfma_f32_4x4x4_16b_bf16 v[112:115], a[80:81], v[116:117], v[112:115]
  v_mfma_f32_4x4x4_16b_bf16 v[104:107], a[50:51], v[116:117], v[104:107]
  v_mfma_f32_4x4x4_16b_bf16 v[108:111], a[66:67], v[116:117], v[108:111]
  v_mfma_f32_4x4x4_16b_bf16 v[112:115], a[82:83], v[116:117], v[112:115]
Lcs_7:
  s_cmp_lg_u32 s70, 1
  s_cbranch_scc1 Lcs_8
  v_mfma_f32_4x4x4_16b_bf16 v[104:107], a[52:53], v[116:117], v[104:107]
  v_mfma_f32_4x4x4_16b_bf16 v[108:111], a[68:69], v[116:117], v[108:111]
  v_mfma_f32_4x4x4_16b_bf16 v[112:115], a[84:85], v[116:117], v[112:115]
  v_mfma_f32_4x4x4_16b_bf16 v[104:107], a[54:55], v[116:117], v[104:107]
  v_mfma_f32_4x4x4_16b_bf16 v[108:111], a[70:71], v[116:117], v[108:111]
  v_mfma_f32_4x4x4_16b_bf16 v[112:115], a[86:87], v[116:117], v[112:115]
Lcs_8:
  s_cmp_lg_u32 s70, 2
  s_cbranch_scc1 Lcs_9
  v_mfma_f32_4x4x4_16b_bf16 v[104:107], a[56:57], v[116:117], v[104:107]
  v_mfma_f32_4x4x4_16b_bf16 v[108:111], a[72:73], v[116:117], v[108:111]
  v_mfma_f32_4x4x4_16b_bf16 v[112:115], a[88:89], v[116:117], v[112:115]
  v_mfma_f32_4x4x4_16b_bf16 v[104:107], a[58:59], v[116:117], v[104:107]
  v_mfma_f32_4x4x4_16b_bf16 v[108:111], a[74:75], v[116:117], v[108:111]
  v_mfma_f32_4x4x4_16b_bf16 v[112:115], a[90:91], v[116:117], v[112:115]
Lcs_9:
  s_cmp_lg_u32 s70, 3
  s_cbranch_scc1 Lcs_10
  v_mfma_f32_4x4x4_16b_bf16 v[104:107], a[60:61], v[116:117], v[104:107]
  v_mfma_f32_4x4x4_16b_bf16 v[108:111], a[76:77], v[116:117], v[108:111]
  v_mfma_f32_4x4x4_16b_bf16 v[112:115], a[92:93], v[116:117], v[112:115]
  v_mfma_f32_4x4x4_16b_bf16 v[104:107], a[62:63], v[116:117], v[104:107]
  v_mfma_f32_4x4x4_16b_bf16 v[108:111], a[78:79], v[116:117], v[108:111]
  v_mfma_f32_4x4x4_16b_bf16 v[112:115], a[94:95], v[116:117], v[112:115]
Lcs_10:
  s_add_u32 m0, s75, -512
  s_nop 0
  buffer_load_dwordx4 v121, s[28:31], s78 offen offset:512 lds
  ds_read_b128 v[64:67], v123 offset:8192
  ds_read_b128 v[68:71], v124 offset:8192
  v_mfma_f32_32x32x16_bf16 v[32:47], a[72:75], v[88:91], v[32:47]
  ds_read_b128 v[72:75], v125 offset:8192
  ds_read_b128 v[76:79], v126 offset:8192
  s_add_u32 m0, s75, 512
  s_nop 0
  buffer_load_dwordx4 v122, s[28:31], s79 offen offset:512 lds
  v_mfma_f32_32x32x16_bf16 v[16:31], a[56:59], v[88:91], v[16:31]
  ds_read_b64_tr_b16 a[8:9], v127 offset:30720
  ds_read_b64_tr_b16 a[10:11], v127 offset:31488
  ds_read_b64_tr_b16 a[12:13], v127 offset:33792
  v_mfma_f32_32x32x16_bf16 v[48:63], v[88:91], a[88:91], v[48:63]
  ds_read_b64_tr_b16 a[14:15], v127 offset:34560
  ds_read_b64_tr_b16 a[32:33], v127 offset:24704
  s_add_u32 m0, s75, 1536
  s_nop 0
  buffer_load_dwordx4 v121, s[28:31], s80 offen offset:512 lds
  v_mfma_f32_32x32x16_bf16 v[32:47], a[76:79], v[92:95], v[32:47]
  ds_read_b64_tr_b16 a[34:35], v127 offset:25472
  ds_read_b64_tr_b16 a[36:37], v127 offset:27776
  ds_read_b64_tr_b16 a[38:39], v127 offset:28544
  v_mfma_f32_32x32x16_bf16 v[16:31], a[60:63], v[92:95], v[16:31]
  ds_read_b64_tr_b16 a[40:41], v127 offset:30848
  s_add_u32 m0, s75, 2560
  s_nop 0
  buffer_load_dwordx4 v122, s[28:31], s81 offen offset:512 lds
  ds_read_b64_tr_b16 a[42:43], v127 offset:31616
  v_mfma_f32_32x32x16_bf16 v[48:63], v[92:95], a[92:95], v[48:63]
  ds_read_b64_tr_b16 a[44:45], v127 offset:33920
  ds_read_b64_tr_b16 a[46:47], v127 offset:34688
  s_waitcnt vmcnt(14)
  ds_write_b16 v129, v116 offset:36864
  s_waitcnt lgkmcnt(0)
  v_mfma_f32_32x32x16_bf16 v[32:47], a[16:19], v[64:67], v[32:47]
  s_add_u32 s89, s76, 1032192
  s_add_u32 m0, s77, 73728
  s_nop 0
  buffer_load_dwordx4 v118, s[32:35], s89 offen sc1 lds
  s_barrier
  ds_read_b64_tr_b16 a[64:65], v127 offset:36928
  v_mfma_f32_32x32x16_bf16 v[16:31], a[0:3], v[64:67], v[16:31]
  ds_read_b64_tr_b16 a[66:67], v127 offset:37696
  s_add_u32 m0, s77, 74752
  s_nop 0
  buffer_load_dwordx4 v119, s[32:35], s89 offen sc1 lds
  ds_read_b64_tr_b16 a[68:69], v127 offset:40000
  v_mfma_f32_32x32x16_bf16 v[48:63], v[64:67], a[32:35], v[48:63]
  ds_read_b64_tr_b16 a[70:71], v127 offset:40768
  ds_read_b64_tr_b16 a[72:73], v127 offset:43072
  s_add_u32 m0, s77, 75776
  s_nop 0
  buffer_load_dwordx4 v120, s[32:35], s89 offen sc1 lds
  v_mfma_f32_32x32x16_bf16 v[32:47], a[20:23], v[68:71], v[32:47]
  ds_read_b64_tr_b16 a[74:75], v127 offset:43840
  ds_read_b64_tr_b16 a[76:77], v127 offset:46144
  ds_read_b64_tr_b16 a[78:79], v127 offset:46912
  v_mfma_f32_32x32x16_bf16 v[16:31], a[4:7], v[68:71], v[16:31]
  s_add_u32 m0, s75, 3456
  s_nop 0
  buffer_load_dwordx4 v121, s[28:31], s78 offen offset:640 lds
  ds_read_b64_tr_b16 a[48:49], v127 offset:36864
  ds_read_b64_tr_b16 a[50:51], v127 offset:37632
  ds_read_b64_tr_b16 a[52:53], v127 offset:39936
  v_mfma_f32_32x32x16_bf16 v[48:63], v[68:71], a[36:39], v[48:63]
  s_add_u32 m0, s75, 4480
  s_nop 0
  buffer_load_dwordx4 v122, s[28:31], s79 offen offset:640 lds
  ds_read_b64_tr_b16 a[54:55], v127 offset:40704
  s_waitcnt vmcnt(12)
  v_mfma_f32_4x4x4_16b_bf16 v[96:99], v[64:65], v[64:65], v[96:99]
  v_mfma_f32_4x4x4_16b_bf16 v[100:103], v[66:67], v[66:67], v[100:103]
  s_nop 0
  v_mfma_f32_4x4x4_16b_bf16 v[96:99], v[68:69], v[68:69], v[96:99]
  v_mfma_f32_4x4x4_16b_bf16 v[100:103], v[70:71], v[70:71], v[100:103]
  s_nop 0
  v_mfma_f32_4x4x4_16b_bf16 v[96:99], v[72:73], v[72:73], v[96:99]
  v_mfma_f32_4x4x4_16b_bf16 v[100:103], v[74:75], v[74:75], v[100:103]
  s_nop 0
  v_mfma_f32_4x4x4_16b_bf16 v[96:99], v[76:77], v[76:77], v[96:99]
  v_mfma_f32_4x4x4_16b_bf16 v[100:103], v[78:79], v[78:79], v[100:103]
  s_cmp_lg_u32 s70, 0
  s_cbranch_scc1 Lcs_11
  v_mfma_f32_4x4x4_16b_bf16 v[104:107], a[0:1], v[116:117], v[104:107]
  v_mfma_f32_4x4x4_16b_bf16 v[108:111], a[16:17], v[116:117], v[108:111]
  v_mfma_f32_4x4x4_16b_bf16 v[112:115], a[32:33], v[116:117], v[112:115]
  v_mfma_f32_4x4x4_16b_bf16 v[104:107], a[2:3], v[116:117], v[104:107]
  v_mfma_f32_4x4x4_16b_bf16 v[108:111], a[18:19], v[116:117], v[108:111]
  v_mfma_f32_4x4x4_16b_bf16 v[112:115], a[34:35], v[116:117], v[112:115]
Lcs_11:
  s_cmp_lg_u32 s70, 1
  s_cbranch_scc1 Lcs_12
  v_mfma_f32_4x4x4_16b_bf16 v[104:107], a[4:5], v[116:117], v[104:107]
  v_mfma_f32_4x4x4_16b_bf16 v[108:111], a[20:21], v[116:117], v[108:111]
  v_mfma_f32_4x4x4_16b_bf16 v[112:115], a[36:37], v[116:117], v[112:115]
  v_mfma_f32_4x4x4_16b_bf16 v[104:107], a[6:7], v[116:117], v[104:107]
  v_mfma_f32_4x4x4_16b_bf16 v[108:111], a[22:23], v[116:117], v[108:111]
  v_mfma_f32_4x4x4_16b_bf16 v[112:115], a[38:39], v[116:117], v[112:115]
Lcs_12:
  s_cmp_lg_u32 s70, 2
  s_cbranch_scc1 Lcs_13
  v_mfma_f32_4x4x4_16b_bf16 v[104:107], a[8:9], v[116:117], v[104:107]
  v_mfma_f32_4x4x4_16b_bf16 v[108:111], a[24:25], v[116:117], v[108:111]
  v_mfma_f32_4x4x4_16b_bf16 v[112:115], a[40:41], v[116:117], v[112:115]
  v_mfma_f32_4x4x4_16b_bf16 v[104:107], a[10:11], v[116:117], v[104:107]
  v_mfma_f32_4x4x4_16b_bf16 v[108:111], a[26:27], v[116:117], v[108:111]
  v_mfma_f32_4x4x4_16b_bf16 v[112:115], a[42:43], v[116:117], v[112:115]
Lcs_13:
  s_cmp_lg_u32 s70, 3
  s_cbranch_scc1 Lcs_14
  v_mfma_f32_4x4x4_16b_bf16 v[104:107], a[12:13], v[116:117], v[104:107]
  v_mfma_f32_4x4x4_16b_bf16 v[108:111], a[28:29], v[116:117], v[108:111]
  v_mfma_f32_4x4x4_16b_bf16 v[112:115], a[44:45], v[116:117], v[112:115]
  v_mfma_f32_4x4x4_16b_bf16 v[104:107], a[14:15], v[116:117], v[104:107]
  v_mfma_f32_4x4x4_16b_bf16 v[108:111], a[30:31], v[116:117], v[108:111]
  v_mfma_f32_4x4x4_16b_bf16 v[112:115], a[46:47], v[116:117], v[112:115]
Lcs_14:
  ds_read_b128 v[80:83], v123 offset:12288
  s_add_u32 m0, s75, 5504
  s_nop 0
  buffer_load_dwordx4 v121, s[28:31], s80 offen offset:640 lds
  ds_read_b128 v[84:87], v124 offset:12288
  v_mfma_f32_32x32x16_bf16 v[32:47], a[24:27], v[72:75], v[32:47]
  ds_read_b128 v[88:91], v125 offset:12288
  s_add_u32 m0, s75, 6528
  s_nop 0
  buffer_load_dwordx4 v122, s[28:31], s81 offen offset:640 lds
  ds_read_b128 v[92:95], v126 offset:12288
  v_mfma_f32_32x32x16_bf16 v[16:31], a[8:11], v[72:75], v[16:31]
  ds_read_b64_tr_b16 a[56:57], v127 offset:43008
  ds_read_b64_tr_b16 a[58:59], v127 offset:43776
  v_lshlrev_b32 v140, 21, v1
  v_min_u32 v140, 20971520, v140
  buffer_load_dword v239, v140, s[60:63], 0 offen
  ds_read_b64_tr_b16 a[60:61], v127 offset:46080
  v_mfma_f32_32x32x16_bf16 v[48:63], v[72:75], a[40:43], v[48:63]
  ds_read_b64_tr_b16 a[62:63], v127 offset:46848
  ds_read_b64_tr_b16 a[80:81], v127 offset:36992
  v_lshlrev_b32 v141, 21, v1
  buffer_load_dword v239, v141, s[56:59], 0 offen
  v_mfma_f32_32x32x16_bf16 v[32:47], a[28:31], v[76:79], v[32:47]
  ds_read_b64_tr_b16 a[82:83], v127 offset:37760
  ds_read_b64_tr_b16 a[84:85], v127 offset:40064
  ds_read_b64_tr_b16 a[86:87], v127 offset:40832
  v_mfma_f32_32x32x16_bf16 v[16:31], a[12:15], v[76:79], v[16:31]
  v_lshlrev_b32 v141, 21, v1
  buffer_load_dword v239, v141, s[44:47], 0 offen
  ds_read_b64_tr_b16 a[88:89], v127 offset:43136
  ds_read_b64_tr_b16 a[90:91], v127 offset:43904
  v_mfma_f32_32x32x16_bf16 v[48:63], v[76:79], a[44:47], v[48:63]
  ds_read_b64_tr_b16 a[92:93], v127 offset:46208
  v_lshlrev_b32 v141, 21, v1
  buffer_load_dword v239, v141, s[52:55], 0 offen
  ds_read_b64_tr_b16 a[94:95], v127 offset:46976
  ds_write_b16 v129, v116 offset:49152
  s_cmp_eq_u32 s12, 0
  s_cbranch_scc1 Lw2s_15
  v_lshl_add_u32 v138, v231, 2, v232
  v_mul_u32_u24 v138, 224, v138
  v_lshl_add_u32 v138, v233, 3, v138
  v_add_u32 v138, 151552, v138
  ds_read_b64_tr_b16 v[172:173], v138 offset:0
  ds_read_b64_tr_b16 v[174:175], v138 offset:3584
  ds_read_b64_tr_b16 v[176:177], v138 offset:32
  ds_read_b64_tr_b16 v[178:179], v138 offset:3616
  ds_read_b64_tr_b16 v[180:181], v138 offset:64
  ds_read_b64_tr_b16 v[182:183], v138 offset:3648
  ds_read_b64_tr_b16 v[184:185], v138 offset:96
  ds_read_b64_tr_b16 v[186:187], v138 offset:3680
  ds_read_b64_tr_b16 v[188:189], v138 offset:128
  ds_read_b64_tr_b16 v[190:191], v138 offset:3712
  ds_read_b64_tr_b16 v[192:193], v138 offset:160
  ds_read_b64_tr_b16 v[194:195], v138 offset:3744
  ds_read_b64_tr_b16 v[196:197], v138 offset:192
  ds_read_b64_tr_b16 v[198:199], v138 offset:3776
  s_mul_i32 s71, s10, 28
  s_mul_i32 s72, s11, 7
  s_add_u32 s71, s71, s72
  s_lshl_b32 s71, s71, 10
  s_add_u32 s71, s71, 17825792
  v_lshlrev_b32 v139, 4, v1
  s_waitcnt lgkmcnt(0)
  s_add_u32 s72, s71, 0
  buffer_store_dwordx4 v[172:175], v139, s[60:63], s72 offen offset:0 sc1
  s_add_u32 s72, s71, 0
  buffer_store_dwordx4 v[176:179], v139, s[60:63], s72 offen offset:1024 sc1
  s_add_u32 s72, s71, 0
  buffer_store_dwordx4 v[180:183], v139, s[60:63], s72 offen offset:2048 sc1
  s_add_u32 s72, s71, 0
  buffer_store_dwordx4 v[184:187], v139, s[60:63], s72 offen offset:3072 sc1
  s_add_u32 s72, s71, 4096
  buffer_store_dwordx4 v[188:191], v139, s[60:63], s72 offen offset:0 sc1
  s_add_u32 s72, s71, 4096
  buffer_store_dwordx4 v[192:195], v139, s[60:63], s72 offen offset:1024 sc1
  s_add_u32 s72, s71, 4096
  buffer_store_dwordx4 v[196:199], v139, s[60:63], s72 offen offset:2048 sc1
Lw2s_15:
  s_waitcnt lgkmcnt(0)
  v_mfma_f32_32x32x16_bf16 v[32:47], a[64:67], v[80:83], v[32:47]
  s_add_u32 m0, s75, 7424
  s_nop 0
  buffer_load_dwordx4 v121, s[28:31], s78 offen offset:768 lds
  s_barrier
  v_mfma_f32_32x32x16_bf16 v[16:31], a[48:51], v[80:83], v[16:31]
  ds_read_b64_tr_b16 a[16:17], v127 offset:49216
  ds_read_b64_tr_b16 a[18:19], v127 offset:49984
  ds_read_b64_tr_b16 a[20:21], v127 offset:52288
  v_mfma_f32_32x32x16_bf16 v[48:63], v[80:83], a[80:83], v[48:63]
  ds_read_b64_tr_b16 a[22:23], v127 offset:53056
  s_add_u32 m0, s75, 8448
  s_nop 0
  buffer_load_dwordx4 v122, s[28:31], s79 offen offset:768 lds
  ds_read_b64_tr_b16 a[24:25], v127 offset:55360
  v_mfma_f32_32x32x16_bf16 v[32:47], a[68:71], v[84:87], v[32:47]
  ds_read_b64_tr_b16 a[26:27], v127 offset:56128
  ds_read_b64_tr_b16 a[28:29], v127 offset:58432
  ds_read_b64_tr_b16 a[30:31], v127 offset:59200
  v_mfma_f32_32x32x16_bf16 v[16:31], a[52:55], v[84:87], v[16:31]
  s_add_u32 m0, s75, 9472
  s_nop 0
  buffer_load_dwordx4 v121, s[28:31], s80 offen offset:768 lds
  ds_read_b64_tr_b16 a[0:1], v127 offset:49152
  ds_read_b64_tr_b16 a[2:3], v127 offset:49920
  v_mfma_f32_32x32x16_bf16 v[48:63], v[84:87], a[84:87], v[48:63]
  ds_read_b64_tr_b16 a[4:5], v127 offset:52224
  ds_read_b64_tr_b16 a[6:7], v127 offset:52992
  s_waitcnt vmcnt(14)
  v_mfma_f32_4x4x4_16b_bf16 v[96:99], v[80:81], v[80:81], v[96:99]
  v_mfma_f32_4x4x4_16b_bf16 v[100:103], v[82:83], v[82:83], v[100:103]
  s_nop 0
  v_mfma_f32_4x4x4_16b_bf16 v[96:99], v[84:85], v[84:85], v[96:99]
  v_mfma_f32_4x4x4_16b_bf16 v[100:103], v[86:87], v[86:87], v[100:103]
  s_nop 0
  v_mfma_f32_4x4x4_16b_bf16 v[96:99], v[88:89], v[88:89], v[96:99]
  v_mfma_f32_4x4x4_16b_bf16 v[100:103], v[90:91], v[90:91], v[100:103]
  s_nop 0
  v_mfma_f32_4x4x4_16b_bf16 v[96:99], v[92:93], v[92:93], v[96:99]
  v_mfma_f32_4x4x4_16b_bf16 v[100:103], v[94:95], v[94:95], v[100:103]
  s_cmp_lg_u32 s70, 0
  s_cbranch_scc1 Lcs_16
  v_mfma_f32_4x4x4_16b_bf16 v[104:107], a[48:49], v[116:117], v[104:107]
  v_mfma_f32_4x4x4_16b_bf16 v[108:111], a[64:65], v[116:117], v[108:111]
  v_mfma_f32_4x4x4_16b_bf16 v[112:115], a[80:81], v[116:117], v[112:115]
  v_mfma_f32_4x4x4_16b_bf16 v[104:107], a[50:51], v[116:117], v[104:107]
  v_mfma_f32_4x4x4_16b_bf16 v[108:111], a[66:67], v[116:117], v[108:111]
  v_mfma_f32_4x4x4_16b_bf16 v[112:115], a[82:83], v[116:117], v[112:115]
Lcs_16:
  s_cmp_lg_u32 s70, 1
  s_cbranch_scc1 Lcs_17
  v_mfma_f32_4x4x4_16b_bf16 v[104:107], a[52:53], v[116:117], v[104:107]
  v_mfma_f32_4x4x4_16b_bf16 v[108:111], a[68:69], v[116:117], v[108:111]
  v_mfma_f32_4x4x4_16b_bf16 v[112:115], a[84:85], v[116:117], v[112:115]
  v_mfma_f32_4x4x4_16b_bf16 v[104:107], a[54:55], v[116:117], v[104:107]
  v_mfma_f32_4x4x4_16b_bf16 v[108:111], a[70:71], v[116:117], v[108:111]
  v_mfma_f32_4x4x4_16b_bf16 v[112:115], a[86:87], v[116:117], v[112:115]
Lcs_17:
  s_cmp_lg_u32 s70, 2
  s_cbranch_scc1 Lcs_18
  v_mfma_f32_4x4x4_16b_bf16 v[104:107], a[56:57], v[116:117], v[104:107]
  v_mfma_f32_4x4x4_16b_bf16 v[108:111], a[72:73], v[116:117], v[108:111]
  v_mfma_f32_4x4x4_16b_bf16 v[112:115], a[88:89], v[116:117], v[112:115]
  v_mfma_f32_4x4x4_16b_bf16 v[104:107], a[58:59], v[116:117], v[104:107]
  v_mfma_f32_4x4x4_16b_bf16 v[108:111], a[74:75], v[116:117], v[108:111]
  v_mfma_f32_4x4x4_16b_bf16 v[112:115], a[90:91], v[116:117], v[112:115]
Lcs_18:
  s_cmp_lg_u32 s70, 3
  s_cbranch_scc1 Lcs_19
  v_mfma_f32_4x4x4_16b_bf16 v[104:107], a[60:61], v[116:117], v[104:107]
  v_mfma_f32_4x4x4_16b_bf16 v[108:111], a[76:77], v[116:117], v[108:111]
  v_mfma_f32_4x4x4_16b_bf16 v[112:115], a[92:93], v[116:117], v[112:115]
  v_mfma_f32_4x4x4_16b_bf16 v[104:107], a[62:63], v[116:117], v[104:107]
  v_mfma_f32_4x4x4_16b_bf16 v[108:111], a[78:79], v[116:117], v[108:111]
  v_mfma_f32_4x4x4_16b_bf16 v[112:115], a[94:95], v[116:117], v[112:115]
Lcs_19:
  s_add_u32 m0, s75, 10496
  s_nop 0
  buffer_load_dwordx4 v122, s[28:31], s81 offen offset:768 lds
  ds_read_b128 v[64:67], v123 offset:0
  ds_read_b128 v[68:71], v124 offset:0
  v_mfma_f32_32x32x16_bf16 v[32:47], a[72:75], v[88:91], v[32:47]
  ds_read_b128 v[72:75], v125 offset:0
  ds_read_b128 v[76:79], v126 offset:0
  v_mov_b32 v251, 0
  buffer_load_dwordx2 v[252:253], v251, s[64:67], 0 offen sc1
  v_mfma_f32_32x32x16_bf16 v[16:31], a[56:59], v[88:91], v[16:31]
  ds_read_b64_tr_b16 a[8:9], v127 offset:55296
  ds_read_b64_tr_b16 a[10:11], v127 offset:56064
  ds_read_b64_tr_b16 a[12:13], v127 offset:58368
  v_mfma_f32_32x32x16_bf16 v[48:63], v[88:91], a[88:91], v[48:63]
  ds_read_b64_tr_b16 a[14:15], v127 offset:59136
  ds_read_b64_tr_b16 a[32:33], v127 offset:49280
  s_mul_i32 s74, s95, 14
  v_min_u32 v152, 13, v1
  v_add_u32 v152, s74, v152
  v_lshrrev_b32 v150, 2, v152
  v_and_b32 v152, 3, v152
  v_lshlrev_b32 v152, 7, v152
  v_mul_u32_u24 v150, 896, v150
  v_add_u32 v152, v152, v150
  s_bfe_u32 s74, s2, 0x10002
  s_lshl_b32 s74, s74, 9
  buffer_load_dword v239, v152, s[36:39], s74 offen
  v_mfma_f32_32x32x16_bf16 v[32:47], a[76:79], v[92:95], v[32:47]
  ds_read_b64_tr_b16 a[34:35], v127 offset:50048
  ds_read_b64_tr_b16 a[36:37], v127 offset:52352
  ds_read_b64_tr_b16 a[38:39], v127 offset:53120
  v_mfma_f32_32x32x16_bf16 v[16:31], a[60:63], v[92:95], v[16:31]
  ds_read_b64_tr_b16 a[40:41], v127 offset:55424
  s_mul_i32 s74, s95, 49
  v_min_u32 v152, 48, v1
  v_add_u32 v152, s74, v152
  v_mul_u32_u24 v150, 18725, v152
  v_lshrrev_b32 v150, 18, v150
  v_mul_u32_u24 v151, 14, v150
  v_sub_u32 v152, v152, v151
  v_lshlrev_b32 v152, 7, v152
  v_mul_u32_u24 v150, 3584, v150
  v_add_u32 v152, v152, v150
  s_bfe_u32 s74, s2, 0x10002
  s_mul_i32 s74, s74, 1792
  buffer_load_dword v239, v152, s[40:43], s74 offen
  ds_read_b64_tr_b16 a[42:43], v127 offset:56192
  v_mfma_f32_32x32x16_bf16 v[48:63], v[92:95], a[92:95], v[48:63]
  ds_read_b64_tr_b16 a[44:45], v127 offset:58496
  ds_read_b64_tr_b16 a[46:47], v127 offset:59264
  ds_write_b16 v234, v116 offset:0
  s_waitcnt lgkmcnt(0)
  v_mfma_f32_32x32x16_bf16 v[32:47], a[16:19], v[64:67], v[32:47]
  s_barrier
  ds_read_b64_tr_b16 a[64:65], v128 offset:64
  v_mfma_f32_32x32x16_bf16 v[16:31], a[0:3], v[64:67], v[16:31]
  ds_read_b64_tr_b16 a[66:67], v128 offset:832
  ds_read_b64_tr_b16 a[68:69], v128 offset:3136
  v_mfma_f32_32x32x16_bf16 v[48:63], v[64:67], a[32:35], v[48:63]
  ds_read_b64_tr_b16 a[70:71], v128 offset:3904
  ds_read_b64_tr_b16 a[72:73], v128 offset:6208
  ds_read_b64_tr_b16 a[74:75], v128 offset:6976
  v_mfma_f32_32x32x16_bf16 v[32:47], a[20:23], v[68:71], v[32:47]
  ds_read_b64_tr_b16 a[76:77], v128 offset:9280
  ds_read_b64_tr_b16 a[78:79], v128 offset:10048
  v_mfma_f32_32x32x16_bf16 v[16:31], a[4:7], v[68:71], v[16:31]
  ds_read_b64_tr_b16 a[48:49], v128 offset:0
  ds_read_b64_tr_b16 a[50:51], v128 offset:768
  v_mfma_f32_32x32x16_bf16 v[48:63], v[68:71], a[36:39], v[48:63]
  ds_read_b64_tr_b16 a[52:53], v128 offset:3072
  ds_read_b64_tr_b16 a[54:55], v128 offset:3840
  s_waitcnt vmcnt(11)
  v_mfma_f32_4x4x4_16b_bf16 v[96:99], v[64:65], v[64:65], v[96:99]
  v_mfma_f32_4x4x4_16b_bf16 v[100:103], v[66:67], v[66:67], v[100:103]
  s_nop 0
  v_mfma_f32_4x4x4_16b_bf16 v[96:99], v[68:69], v[68:69], v[96:99]
  v_mfma_f32_4x4x4_16b_bf16 v[100:103], v[70:71], v[70:71], v[100:103]
  s_nop 0
  v_mfma_f32_4x4x4_16b_bf16 v[96:99], v[72:73], v[72:73], v[96:99]
  v_mfma_f32_4x4x4_16b_bf16 v[100:103], v[74:75], v[74:75], v[100:103]
  s_nop 0
  v_mfma_f32_4x4x4_16b_bf16 v[96:99], v[76:77], v[76:77], v[96:99]
  v_mfma_f32_4x4x4_16b_bf16 v[100:103], v[78:79], v[78:79], v[100:103]
  s_cmp_lg_u32 s70, 0
  s_cbranch_scc1 Lcs_20
  v_mfma_f32_4x4x4_16b_bf16 v[104:107], a[0:1], v[116:117], v[104:107]
  v_mfma_f32_4x4x4_16b_bf16 v[108:111], a[16:17], v[116:117], v[108:111]
  v_mfma_f32_4x4x4_16b_bf16 v[112:115], a[32:33], v[116:117], v[112:115]
  v_mfma_f32_4x4x4_16b_bf16 v[104:107], a[2:3], v[116:117], v[104:107]
  v_mfma_f32_4x4x4_16b_bf16 v[108:111], a[18:19], v[116:117], v[108:111]
  v_mfma_f32_4x4x4_16b_bf16 v[112:115], a[34:35], v[116:117], v[112:115]
Lcs_20:
  s_cmp_lg_u32 s70, 1
  s_cbranch_scc1 Lcs_21
  v_mfma_f32_4x4x4_16b_bf16 v[104:107], a[4:5], v[116:117], v[104:107]
  v_mfma_f32_4x4x4_16b_bf16 v[108:111], a[20:21], v[116:117], v[108:111]
  v_mfma_f32_4x4x4_16b_bf16 v[112:115], a[36:37], v[116:117], v[112:115]
  v_mfma_f32_4x4x4_16b_bf16 v[104:107], a[6:7], v[116:117], v[104:107]
  v_mfma_f32_4x4x4_16b_bf16 v[108:111], a[22:23], v[116:117], v[108:111]
  v_mfma_f32_4x4x4_16b_bf16 v[112:115], a[38:39], v[116:117], v[112:115]
Lcs_21:
  s_cmp_lg_u32 s70, 2
  s_cbranch_scc1 Lcs_22
  v_mfma_f32_4x4x4_16b_bf16 v[104:107], a[8:9], v[116:117], v[104:107]
  v_mfma_f32_4x4x4_16b_bf16 v[108:111], a[24:25], v[116:117], v[108:111]
  v_mfma_f32_4x4x4_16b_bf16 v[112:115], a[40:41], v[116:117], v[112:115]
  v_mfma_f32_4x4x4_16b_bf16 v[104:107], a[10:11], v[116:117], v[104:107]
  v_mfma_f32_4x4x4_16b_bf16 v[108:111], a[26:27], v[116:117], v[108:111]
  v_mfma_f32_4x4x4_16b_bf16 v[112:115], a[42:43], v[116:117], v[112:115]
Lcs_22:
  s_cmp_lg_u32 s70, 3
  s_cbranch_scc1 Lcs_23
  v_mfma_f32_4x4x4_16b_bf16 v[104:107], a[12:13], v[116:117], v[104:107]
  v_mfma_f32_4x4x4_16b_bf16 v[108:111], a[28:29], v[116:117], v[108:111]
  v_mfma_f32_4x4x4_16b_bf16 v[112:115], a[44:45], v[116:117], v[112:115]
  v_mfma_f32_4x4x4_16b_bf16 v[104:107], a[14:15], v[116:117], v[104:107]
  v_mfma_f32_4x4x4_16b_bf16 v[108:111], a[30:31], v[116:117], v[108:111]
  v_mfma_f32_4x4x4_16b_bf16 v[112:115], a[46:47], v[116:117], v[112:115]
Lcs_23:
  ds_read_b128 v[80:83], v123 offset:4096
  ds_read_b128 v[84:87], v124 offset:4096
  v_mfma_f32_32x32x16_bf16 v[32:47], a[24:27], v[72:75], v[32:47]
  ds_read_b128 v[88:91], v125 offset:4096
  ds_read_b128 v[92:95], v126 offset:4096
  ds_read_b64_tr_b16 a[56:57], v128 offset:6144
  v_mfma_f32_32x32x16_bf16 v[16:31], a[8:11], v[72:75], v[16:31]
  ds_read_b64_tr_b16 a[58:59], v128 offset:6912
  ds_read_b64_tr_b16 a[60:61], v128 offset:9216
  v_mfma_f32_32x32x16_bf16 v[48:63], v[72:75], a[40:43], v[48:63]
  ds_read_b64_tr_b16 a[62:63], v128 offset:9984
  ds_read_b64_tr_b16 a[80:81], v128 offset:128
  v_mfma_f32_32x32x16_bf16 v[32:47], a[28:31], v[76:79], v[32:47]
  ds_read_b64_tr_b16 a[82:83], v128 offset:896
  ds_read_b64_tr_b16 a[84:85], v128 offset:3200
  ds_read_b64_tr_b16 a[86:87], v128 offset:3968
  v_mfma_f32_32x32x16_bf16 v[16:31], a[12:15], v[76:79], v[16:31]
  ds_read_b64_tr_b16 a[88:89], v128 offset:6272
  ds_read_b64_tr_b16 a[90:91], v128 offset:7040
  v_mfma_f32_32x32x16_bf16 v[48:63], v[76:79], a[44:47], v[48:63]
  ds_read_b64_tr_b16 a[92:93], v128 offset:9344
  ds_read_b64_tr_b16 a[94:95], v128 offset:10112
  ds_write_b16 v234, v116 offset:12288
  s_waitcnt lgkmcnt(0)
  v_mfma_f32_32x32x16_bf16 v[32:47], a[64:67], v[80:83], v[32:47]
  s_barrier
  ds_read_b64_tr_b16 a[16:17], v128 offset:12352
  v_mfma_f32_32x32x16_bf16 v[16:31], a[48:51], v[80:83], v[16:31]
  ds_read_b64_tr_b16 a[18:19], v128 offset:13120
  ds_read_b64_tr_b16 a[20:21], v128 offset:15424
  v_mfma_f32_32x32x16_bf16 v[48:63], v[80:83], a[80:83], v[48:63]
  ds_read_b64_tr_b16 a[22:23], v128 offset:16192
  ds_read_b64_tr_b16 a[24:25], v128 offset:18496
  v_mfma_f32_32x32x16_bf16 v[32:47], a[68:71], v[84:87], v[32:47]
  ds_read_b64_tr_b16 a[26:27], v128 offset:19264
  ds_read_b64_tr_b16 a[28:29], v128 offset:21568
  ds_read_b64_tr_b16 a[30:31], v128 offset:22336
  v_mfma_f32_32x32x16_bf16 v[16:31], a[52:55], v[84:87], v[16:31]
  ds_read_b64_tr_b16 a[0:1], v128 offset:12288
  ds_read_b64_tr_b16 a[2:3], v128 offset:13056
  v_mfma_f32_32x32x16_bf16 v[48:63], v[84:87], a[84:87], v[48:63]
  ds_read_b64_tr_b16 a[4:5], v128 offset:15360
  ds_read_b64_tr_b16 a[6:7], v128 offset:16128
  v_mfma_f32_4x4x4_16b_bf16 v[96:99], v[80:81], v[80:81], v[96:99]
  v_mfma_f32_4x4x4_16b_bf16 v[100:103], v[82:83], v[82:83], v[100:103]
  s_nop 0
  v_mfma_f32_4x4x4_16b_bf16 v[96:99], v[84:85], v[84:85], v[96:99]
  v_mfma_f32_4x4x4_16b_bf16 v[100:103], v[86:87], v[86:87], v[100:103]
  s_nop 0
  v_mfma_f32_4x4x4_16b_bf16 v[96:99], v[88:89], v[88:89], v[96:99]
  v_mfma_f32_4x4x4_16b_bf16 v[100:103], v[90:91], v[90:91], v[100:103]
  s_nop 0
  v_mfma_f32_4x4x4_16b_bf16 v[96:99], v[92:93], v[92:93], v[96:99]
  v_mfma_f32_4x4x4_16b_bf16 v[100:103], v[94:95], v[94:95], v[100:103]
  s_cmp_lg_u32 s70, 0
  s_cbranch_scc1 Lcs_24
  v_mfma_f32_4x4x4_16b_bf16 v[104:107], a[48:49], v[116:117], v[104:107]
  v_mfma_f32_4x4x4_16b_bf16 v[108:111], a[64:65], v[116:117], v[108:111]
  v_mfma_f32_4x4x4_16b_bf16 v[112:115], a[80:81], v[116:117], v[112:115]
  v_mfma_f32_4x4x4_16b_bf16 v[104:107], a[50:51], v[116:117], v[104:107]
  v_mfma_f32_4x4x4_16b_bf16 v[108:111], a[66:67], v[116:117], v[108:111]
  v_mfma_f32_4x4x4_16b_bf16 v[112:115], a[82:83], v[116:117], v[112:115]
Lcs_24:
  s_cmp_lg_u32 s70, 1
  s_cbranch_scc1 Lcs_25
  v_mfma_f32_4x4x4_16b_bf16 v[104:107], a[52:53], v[116:117], v[104:107]
  v_mfma_f32_4x4x4_16b_bf16 v[108:111], a[68:69], v[116:117], v[108:111]
  v_mfma_f32_4x4x4_16b_bf16 v[112:115], a[84:85], v[116:117], v[112:115]
  v_mfma_f32_4x4x4_16b_bf16 v[104:107], a[54:55], v[116:117], v[104:107]
  v_mfma_f32_4x4x4_16b_bf16 v[108:111], a[70:71], v[116:117], v[108:111]
  v_mfma_f32_4x4x4_16b_bf16 v[112:115], a[86:87], v[116:117], v[112:115]
Lcs_25:
  s_cmp_lg_u32 s70, 2
  s_cbranch_scc1 Lcs_26
  v_mfma_f32_4x4x4_16b_bf16 v[104:107], a[56:57], v[116:117], v[104:107]
  v_mfma_f32_4x4x4_16b_bf16 v[108:111], a[72:73], v[116:117], v[108:111]
  v_mfma_f32_4x4x4_16b_bf16 v[112:115], a[88:89], v[116:117], v[112:115]
  v_mfma_f32_4x4x4_16b_bf16 v[104:107], a[58:59], v[116:117], v[104:107]
  v_mfma_f32_4x4x4_16b_bf16 v[108:111], a[74:75], v[116:117], v[108:111]
  v_mfma_f32_4x4x4_16b_bf16 v[112:115], a[90:91], v[116:117], v[112:115]
Lcs_26:
  s_cmp_lg_u32 s70, 3
  s_cbranch_scc1 Lcs_27
  v_mfma_f32_4x4x4_16b_bf16 v[104:107], a[60:61], v[116:117], v[104:107]
  v_mfma_f32_4x4x4_16b_bf16 v[108:111], a[76:77], v[116:117], v[108:111]
  v_mfma_f32_4x4x4_16b_bf16 v[112:115], a[92:93], v[116:117], v[112:115]
  v_mfma_f32_4x4x4_16b_bf16 v[104:107], a[62:63], v[116:117], v[104:107]
  v_mfma_f32_4x4x4_16b_bf16 v[108:111], a[78:79], v[116:117], v[108:111]
  v_mfma_f32_4x4x4_16b_bf16 v[112:115], a[94:95], v[116:117], v[112:115]
Lcs_27:
  s_waitcnt vmcnt(3)
  ds_read_b128 v[64:67], v123 offset:8192
  ds_read_b128 v[68:71], v124 offset:8192
  v_mfma_f32_32x32x16_bf16 v[32:47], a[72:75], v[88:91], v[32:47]
  ds_read_b128 v[72:75], v125 offset:8192
  ds_read_b128 v[76:79], v126 offset:8192
  v_mfma_f32_32x32x16_bf16 v[16:31], a[56:59], v[88:91], v[16:31]
  ds_read_b64_tr_b16 a[8:9], v128 offset:18432
  ds_read_b64_tr_b16 a[10:11], v128 offset:19200
  v_mfma_f32_32x32x16_bf16 v[48:63], v[88:91], a[88:91], v[48:63]
  ds_read_b64_tr_b16 a[12:13], v128 offset:21504
  ds_read_b64_tr_b16 a[14:15], v128 offset:22272
  ds_read_b64_tr_b16 a[32:33], v128 offset:12416
  v_mfma_f32_32x32x16_bf16 v[32:47], a[76:79], v[92:95], v[32:47]
  ds_read_b64_tr_b16 a[34:35], v128 offset:13184
  ds_read_b64_tr_b16 a[36:37], v128 offset:15488
  v_mfma_f32_32x32x16_bf16 v[16:31], a[60:63], v[92:95], v[16:31]
  ds_read_b64_tr_b16 a[38:39], v128 offset:16256
  ds_read_b64_tr_b16 a[40:41], v128 offset:18560
  v_mfma_f32_32x32x16_bf16 v[48:63], v[92:95], a[92:95], v[48:63]
  ds_read_b64_tr_b16 a[42:43], v128 offset:19328
  ds_read_b64_tr_b16 a[44:45], v128 offset:21632
  ds_read_b64_tr_b16 a[46:47], v128 offset:22400
  s_waitcnt vmcnt(2)
  v_readfirstlane_b32 s5, v253
  v_readfirstlane_b32 s4, v252
  s_nop 1
  s_cmp_lg_u32 s5, 0
  s_cbranch_scc1 Lepok_28
  v_mov_b32 v4, 0
  s_mov_b32 s72, 0
Lefp_29:
  buffer_load_dwordx2 v[2:3], v4, s[64:67], 0 offen sc1
  s_add_u32 s72, s72, 1
  s_cmp_gt_u32 s72, 0x40000
  s_cbranch_scc1 Lend
  s_waitcnt vmcnt(0)
  v_readfirstlane_b32 s5, v3
  v_readfirstlane_b32 s4, v2
  s_nop 1
  s_cmp_eq_u32 s5, 0
  s_cbranch_scc1 Lefp_29
Lepok_28:
  s_cmp_eq_u32 s12, 0
  s_cbranch_scc1 Lw2f_30
  s_lshl_b32 s71, s8, 3
  s_add_u32 s71, s71, 16818176
  v_mov_b32 v2, s4
  v_mov_b32 v3, s5
  v_mov_b32 v4, 0
  s_mov_b64 exec, 1
  buffer_store_dwordx2 v[2:3], v4, s[60:63], s71 offen sc1
  s_mov_b64 exec, -1
Lw2f_30:
  s_waitcnt lgkmcnt(0)
  v_mfma_f32_32x32x16_bf16 v[32:47], a[16:19], v[64:67], v[32:47]
  v_mfma_f32_32x32x16_bf16 v[16:31], a[0:3], v[64:67], v[16:31]
  v_mfma_f32_32x32x16_bf16 v[48:63], v[64:67], a[32:35], v[48:63]
  v_mfma_f32_32x32x16_bf16 v[32:47], a[20:23], v[68:71], v[32:47]
  v_mfma_f32_32x32x16_bf16 v[16:31], a[4:7], v[68:71], v[16:31]
  v_mfma_f32_32x32x16_bf16 v[48:63], v[68:71], a[36:39], v[48:63]
  v_mfma_f32_4x4x4_16b_bf16 v[96:99], v[64:65], v[64:65], v[96:99]
  v_mfma_f32_4x4x4_16b_bf16 v[100:103], v[66:67], v[66:67], v[100:103]
  s_nop 0
  v_mfma_f32_4x4x4_16b_bf16 v[96:99], v[68:69], v[68:69], v[96:99]
  v_mfma_f32_4x4x4_16b_bf16 v[100:103], v[70:71], v[70:71], v[100:103]
  s_nop 0
  v_mfma_f32_4x4x4_16b_bf16 v[96:99], v[72:73], v[72:73], v[96:99]
  v_mfma_f32_4x4x4_16b_bf16 v[100:103], v[74:75], v[74:75], v[100:103]
  s_nop 0
  v_mfma_f32_4x4x4_16b_bf16 v[96:99], v[76:77], v[76:77], v[96:99]
  v_mfma_f32_4x4x4_16b_bf16 v[100:103], v[78:79], v[78:79], v[100:103]
  s_cmp_lg_u32 s70, 0
  s_cbranch_scc1 Lcs_31
  v_mfma_f32_4x4x4_16b_bf16 v[104:107], a[0:1], v[116:117], v[104:107]
  v_mfma_f32_4x4x4_16b_bf16 v[108:111], a[16:17], v[116:117], v[108:111]
  v_mfma_f32_4x4x4_16b_bf16 v[112:115], a[32:33], v[116:117], v[112:115]
  v_mfma_f32_4x4x4_16b_bf16 v[104:107], a[2:3], v[116:117], v[104:107]
  v_mfma_f32_4x4x4_16b_bf16 v[108:111], a[18:19], v[116:117], v[108:111]
  v_mfma_f32_4x4x4_16b_bf16 v[112:115], a[34:35], v[116:117], v[112:115]
Lcs_31:
  s_cmp_lg_u32 s70, 1
  s_cbranch_scc1 Lcs_32
  v_mfma_f32_4x4x4_16b_bf16 v[104:107], a[4:5], v[116:117], v[104:107]
  v_mfma_f32_4x4x4_16b_bf16 v[108:111], a[20:21], v[116:117], v[108:111]
  v_mfma_f32_4x4x4_16b_bf16 v[112:115], a[36:37], v[116:117], v[112:115]
  v_mfma_f32_4x4x4_16b_bf16 v[104:107], a[6:7], v[116:117], v[104:107]
  v_mfma_f32_4x4x4_16b_bf16 v[108:111], a[22:23], v[116:117], v[108:111]
  v_mfma_f32_4x4x4_16b_bf16 v[112:115], a[38:39], v[116:117], v[112:115]
Lcs_32:
  s_cmp_lg_u32 s70, 2
  s_cbranch_scc1 Lcs_33
  v_mfma_f32_4x4x4_16b_bf16 v[104:107], a[8:9], v[116:117], v[104:107]
  v_mfma_f32_4x4x4_16b_bf16 v[108:111], a[24:25], v[116:117], v[108:111]
  v_mfma_f32_4x4x4_16b_bf16 v[112:115], a[40:41], v[116:117], v[112:115]
  v_mfma_f32_4x4x4_16b_bf16 v[104:107], a[10:11], v[116:117], v[104:107]
  v_mfma_f32_4x4x4_16b_bf16 v[108:111], a[26:27], v[116:117], v[108:111]
  v_mfma_f32_4x4x4_16b_bf16 v[112:115], a[42:43], v[116:117], v[112:115]
Lcs_33:
  s_cmp_lg_u32 s70, 3
  s_cbranch_scc1 Lcs_34
  v_mfma_f32_4x4x4_16b_bf16 v[104:107], a[12:13], v[116:117], v[104:107]
  v_mfma_f32_4x4x4_16b_bf16 v[108:111], a[28:29], v[116:117], v[108:111]
  v_mfma_f32_4x4x4_16b_bf16 v[112:115], a[44:45], v[116:117], v[112:115]
  v_mfma_f32_4x4x4_16b_bf16 v[104:107], a[14:15], v[116:117], v[104:107]
  v_mfma_f32_4x4x4_16b_bf16 v[108:111], a[30:31], v[116:117], v[108:111]
  v_mfma_f32_4x4x4_16b_bf16 v[112:115], a[46:47], v[116:117], v[112:115]
Lcs_34:
  v_mfma_f32_32x32x16_bf16 v[32:47], a[24:27], v[72:75], v[32:47]
  v_mfma_f32_32x32x16_bf16 v[16:31], a[8:11], v[72:75], v[16:31]
  v_mfma_f32_32x32x16_bf16 v[48:63], v[72:75], a[40:43], v[48:63]
  v_mfma_f32_32x32x16_bf16 v[32:47], a[28:31], v[76:79], v[32:47]
  v_mfma_f32_32x32x16_bf16 v[16:31], a[12:15], v[76:79], v[16:31]
  v_mfma_f32_32x32x16_bf16 v[48:63], v[76:79], a[44:47], v[48:63]
  v_and_b32 v130, 31, v1
  v_lshrrev_b32 v131, 5, v1
  v_lshlrev_b32 v132, 5, v130
  v_add_u32 v132, 160256, v132
  s_lshl_b32 s71, s70, 3
  v_lshl_add_u32 v133, v131, 2, v132
  v_add_u32 v133, s71, v133
  v_cndmask_b32 v134, v104, v105, s[82:83]
  v_cndmask_b32 v134, v134, v106, s[84:85]
  v_cndmask_b32 v134, v134, v107, s[86:87]
  ds_write_b32 v133, v134 offset:0
  v_cndmask_b32 v135, v108, v109, s[82:83]
  v_cndmask_b32 v135, v135, v110, s[84:85]
  v_cndmask_b32 v135, v135, v111, s[86:87]
  ds_write_b32 v133, v135 offset:1024
  v_cndmask_b32 v136, v112, v113, s[82:83]
  v_cndmask_b32 v136, v136, v114, s[84:85]
  v_cndmask_b32 v136, v136, v115, s[86:87]
  ds_write_b32 v133, v136 offset:2048
  v_add_f32 v96, v96, v100
  v_add_f32 v97, v97, v101
  v_add_f32 v98, v98, v102
  v_add_f32 v99, v99, v103
  v_cndmask_b32 v134, v96, v97, s[82:83]
  v_cndmask_b32 v134, v134, v98, s[84:85]
  v_cndmask_b32 v134, v134, v99, s[86:87]
  v_mov_b32 v135, v134
  v_mov_b32 v136, v44
  v_mov_b32 v137, v44
  v_permlane32_swap_b32 v134, v135
  s_nop 0
  v_permlane32_swap_b32 v136, v137
  v_add_f32 v134, v134, v135
  v_mul_f32 v138, 0x3b124925, v137
  v_mul_f32 v134, 0x3b124925, v134
  v_fma_f32 v134, -v138, v138, v134
  v_max_f32 v134, 0, v134
  v_add_f32 v134, 0x3727c5ac, v134
  v_rsq_f32 v139, v134
  s_lshl_b32 s71, s70, 7
  s_add_u32 s71, s71, 163328
  v_lshlrev_b32 v136, 2, v130
  v_add_u32 v136, s71, v136
  ds_write_b32 v136, v139
  v_sub_f32 v134, 0, v138
  v_cvt_pk_bf16_f32 v135, v134, v134
  v_lshlrev_b32 v135, 16, v135
  v_sub_f32 v135, v134, v135
  v_cvt_pk_bf16_f32 v140, v134, v135
  v_cndmask_b32 v140, v140, 0, s[6:7]
  v_lshlrev_b32 v135, 4, v131
  v_add_u32 v135, s71, v135
  s_waitcnt lgkmcnt(0)
  s_barrier
  ds_read_b128 v[72:75], v132 offset:1024
  ds_read_b128 v[76:79], v132 offset:1040
  ds_read_b128 v[80:83], v132 offset:2048
  ds_read_b128 v[84:87], v132 offset:2064
  ds_read_b128 v[64:67], v132 offset:0
  ds_read_b128 v[68:71], v132 offset:16
  ds_read_b128 v[172:175], v135 offset:0
  ds_read_b128 v[176:179], v135 offset:32
  ds_read_b128 v[180:183], v135 offset:64
  ds_read_b128 v[184:187], v135 offset:96
  v_lshrrev_b32 v141, 3, v1
  v_and_b32 v142, 7, v1
  v_bfe_u32 v143, v141, 1, 2
  v_lshlrev_b32 v143, 1, v143
  v_xor_b32 v142, v142, v143
  v_lshlrev_b32 v142, 4, v142
  v_mul_u32_u24 v141, 896, v141
  v_add3_u32 v236, v141, v142, s91
  s_lshl_b32 s71, s70, 12
  s_add_u32 s71, s71, 111104
  v_lshlrev_b32 v238, 4, v1
  v_add_u32 v237, s71, v238
  s_lshl_b32 s94, s8, 14
  s_add_u32 s94, s94, 12582912
  s_lshl_b32 s74, s70, 12
  s_add_u32 s74, s74, s94
  v_mov_b32 v108, v140
  v_mov_b32 v109, v140
  v_mov_b32 v110, 0
  v_mov_b32 v111, 0
  s_waitcnt lgkmcnt(0)
  v_add_f32 v72, v72, v73
  v_add_f32 v74, v74, v75
  v_add_f32 v76, v76, v77
  v_add_f32 v78, v78, v79
  v_add_f32 v72, v72, v74
  v_add_f32 v76, v76, v78
  v_add_f32 v72, v72, v76
  v_cvt_pk_bf16_f32 v100, v72, v72
  v_lshlrev_b32 v73, 16, v100
  v_sub_f32 v73, v72, v73
  v_cvt_pk_bf16_f32 v101, v73, v73
  v_mov_b32 v102, 0
  v_mov_b32 v103, 0
  s_nop 1
  v_mfma_f32_32x32x16_bf16 v[32:47], v[100:103], v[108:111], v[32:47]
  v_add_f32 v80, v80, v81
  v_add_f32 v82, v82, v83
  v_add_f32 v84, v84, v85
  v_add_f32 v86, v86, v87
  v_add_f32 v80, v80, v82
  v_add_f32 v84, v84, v86
  v_add_f32 v80, v80, v84
  v_cvt_pk_bf16_f32 v104, v80, v80
  v_lshlrev_b32 v81, 16, v104
  v_sub_f32 v81, v80, v81
  v_cvt_pk_bf16_f32 v105, v81, v81
  v_mov_b32 v106, 0
  v_mov_b32 v107, 0
  s_nop 1
  v_mfma_f32_32x32x16_bf16 v[48:63], v[108:111], v[104:107], v[48:63]
  v_add_f32 v64, v64, v65
  v_add_f32 v66, v66, v67
  v_add_f32 v68, v68, v69
  v_add_f32 v70, v70, v71
  v_add_f32 v64, v64, v66
  v_add_f32 v68, v68, v70
  v_add_f32 v64, v64, v68
  v_cvt_pk_bf16_f32 v96, v64, v64
  v_lshlrev_b32 v65, 16, v96
  v_sub_f32 v65, v64, v65
  v_cvt_pk_bf16_f32 v97, v65, v65
  v_mov_b32 v98, 0
  v_mov_b32 v99, 0
  s_nop 1
  v_mfma_f32_32x32x16_bf16 v[16:31], v[96:99], v[108:111], v[16:31]
  v_cmp_eq_u32 s[82:83], 28, v130
  v_mov_b32 v136, 0x3f803f80
  v_mul_f32 v32, v32, v139
  v_mul_f32 v33, v33, v139
  v_mul_f32 v34, v34, v139
  v_mul_f32 v35, v35, v139
  v_mul_f32 v36, v36, v139
  v_mul_f32 v37, v37, v139
  v_mul_f32 v38, v38, v139
  v_mul_f32 v39, v39, v139
  v_mul_f32 v40, v40, v139
  v_mul_f32 v41, v41, v139
  v_mul_f32 v42, v42, v139
  v_mul_f32 v43, v43, v139
  v_mul_f32 v44, v44, v139
  v_mul_f32 v45, v45, v139
  v_mul_f32 v46, v46, v139
  v_mul_f32 v47, v47, v139
  v_cvt_pk_bf16_f32 v64, v32, v33
  v_cvt_pk_bf16_f32 v65, v34, v35
  v_cvt_pk_bf16_f32 v66, v36, v37
  v_cvt_pk_bf16_f32 v67, v38, v39
  v_cvt_pk_bf16_f32 v68, v40, v41
  v_cvt_pk_bf16_f32 v69, v42, v43
  v_cvt_pk_bf16_f32 v70, v44, v45
  v_cvt_pk_bf16_f32 v71, v46, v47
  v_cndmask_b32 v70, v70, 0, s[6:7]
  v_cndmask_b32 v71, v71, 0, s[6:7]
  buffer_store_dwordx4 v[64:67], v238, s[60:63], s74 offen sc1
  buffer_store_dwordx4 v[68:71], v238, s[60:63], s74 offen offset:1024 sc1
  v_mul_f32 v48, v48, v172
  v_mul_f32 v49, v49, v173
  v_mul_f32 v50, v50, v174
  v_mul_f32 v51, v51, v175
  v_mul_f32 v52, v52, v176
  v_mul_f32 v53, v53, v177
  v_mul_f32 v54, v54, v178
  v_mul_f32 v55, v55, v179
  v_mul_f32 v56, v56, v180
  v_mul_f32 v57, v57, v181
  v_mul_f32 v58, v58, v182
  v_mul_f32 v59, v59, v183
  v_mul_f32 v60, v60, v184
  v_mul_f32 v61, v61, v185
  v_mul_f32 v62, v62, v186
  v_mul_f32 v63, v63, v187
  v_cvt_pk_bf16_f32 v72, v48, v49
  v_cvt_pk_bf16_f32 v73, v50, v51
  v_cvt_pk_bf16_f32 v74, v52, v53
  v_cvt_pk_bf16_f32 v75, v54, v55
  v_cvt_pk_bf16_f32 v76, v56, v57
  v_cvt_pk_bf16_f32 v77, v58, v59
  v_cvt_pk_bf16_f32 v78, v60, v61
  v_cvt_pk_bf16_f32 v79, v62, v63
  v_cndmask_b32 v72, v72, v136, s[82:83]
  v_cndmask_b32 v73, v73, v136, s[82:83]
  v_cndmask_b32 v74, v74, v136, s[82:83]
  v_cndmask_b32 v75, v75, v136, s[82:83]
  v_cndmask_b32 v76, v76, v136, s[82:83]
  v_cndmask_b32 v77, v77, v136, s[82:83]
  v_cndmask_b32 v78, v78, v136, s[82:83]
  v_cndmask_b32 v79, v79, v136, s[82:83]
  buffer_store_dwordx4 v[72:75], v238, s[60:63], s74 offen offset:2048 sc1
  buffer_store_dwordx4 v[76:79], v238, s[60:63], s74 offen offset:3072 sc1
  ds_write_b128 v237, v[64:67] offset:32768
  ds_write_b128 v237, v[68:71] offset:33792
  ds_write_b128 v237, v[72:75] offset:34816
  ds_write_b128 v237, v[76:79] offset:35840
  v_mul_f32 v134, 0x3e8b97f6, v139
  v_mul_f32 v16, v16, v134
  v_mul_f32 v17, v17, v134
  v_mul_f32 v18, v18, v134
  v_mul_f32 v19, v19, v134
  v_mul_f32 v20, v20, v134
  v_mul_f32 v21, v21, v134
  v_mul_f32 v22, v22, v134
  v_mul_f32 v23, v23, v134
  v_mul_f32 v24, v24, v134
  v_mul_f32 v25, v25, v134
  v_mul_f32 v26, v26, v134
  v_mul_f32 v27, v27, v134
  v_mul_f32 v28, v28, v134
  v_mul_f32 v29, v29, v134
  v_mul_f32 v30, v30, v134
  v_mul_f32 v31, v31, v134
  v_cvt_pk_bf16_f32 v240, v16, v17
  v_cvt_pk_bf16_f32 v241, v18, v19
  v_cvt_pk_bf16_f32 v242, v20, v21
  v_cvt_pk_bf16_f32 v243, v22, v23
  v_cvt_pk_bf16_f32 v244, v24, v25
  v_cvt_pk_bf16_f32 v245, v26, v27
  v_cvt_pk_bf16_f32 v246, v28, v29
  v_cvt_pk_bf16_f32 v247, v30, v31
  v_cndmask_b32 v246, v246, 0, s[6:7]
  v_cndmask_b32 v247, v247, 0, s[6:7]
  v_and_b32 v133, 0xff, v224
  v_lshrrev_b32 v134, 8, v224
  v_mul_u32_u24 v133, 3584, v133
  v_lshl_add_u32 v224, v134, 4, v133
  v_and_b32 v133, 0xff, v225
  v_lshrrev_b32 v134, 8, v225
  v_mul_u32_u24 v133, 3584, v133
  v_lshl_add_u32 v225, v134, 4, v133
  v_and_b32 v133, 0xff, v226
  v_lshrrev_b32 v134, 8, v226
  v_mul_u32_u24 v133, 3584, v133
  v_lshl_add_u32 v226, v134, 4, v133
  v_and_b32 v133, 0xff, v227
  v_lshrrev_b32 v134, 8, v227
  v_mul_u32_u24 v133, 3584, v133
  v_lshl_add_u32 v227, v134, 4, v133
  v_and_b32 v133, 0xff, v228
  v_lshrrev_b32 v134, 8, v228
  v_mul_u32_u24 v133, 3584, v133
  v_lshl_add_u32 v228, v134, 4, v133
  v_and_b32 v133, 0xff, v229
  v_lshrrev_b32 v134, 8, v229
  v_mul_u32_u24 v133, 3584, v133
  v_lshl_add_u32 v229, v134, 4, v133
  v_and_b32 v133, 0xff, v230
  v_lshrrev_b32 v134, 8, v230
  v_mul_u32_u24 v133, 3584, v133
  v_lshl_add_u32 v230, v134, 4, v133
  s_waitcnt vmcnt(0)
  s_lshl_b32 s71, s8, 5
  s_lshl_b32 s72, s70, 3
  s_add_u32 s71, s71, s72
  s_add_u32 s71, s71, 16777216
  v_mov_b32 v2, s4
  v_mov_b32 v3, s5
  v_mov_b32 v4, 0
  s_mov_b64 exec, 1
  buffer_store_dwordx2 v[2:3], v4, s[60:63], s71 offen sc1
  s_mov_b64 exec, -1
  s_mul_i32 s72, s70, 7168
  s_lshl_b32 s73, s70, 10
  s_add_u32 s71, s72, 0
  s_add_u32 m0, s73, 0
  s_nop 0
  buffer_load_dwordx4 v236, s[36:39], s71 offen lds
  s_mul_i32 s72, s70, 7168
  s_lshl_b32 s73, s70, 10
  s_add_u32 s71, s72, 28672
  s_add_u32 m0, s73, 4096
  s_nop 0
  buffer_load_dwordx4 v236, s[36:39], s71 offen lds
  s_mul_i32 s72, s70, 7168
  s_lshl_b32 s73, s70, 10
  s_add_u32 s71, s72, 57344
  s_add_u32 m0, s73, 8192
  s_nop 0
  buffer_load_dwordx4 v236, s[36:39], s71 offen lds
  s_mul_i32 s72, s70, 7168
  s_lshl_b32 s73, s70, 10
  s_add_u32 s71, s72, 86016
  s_add_u32 m0, s73, 12288
  s_nop 0
  buffer_load_dwordx4 v236, s[36:39], s71 offen lds
  s_mul_i32 s72, s70, 7168
  s_lshl_b32 s73, s70, 10
  s_add_u32 s71, s72, 114688
  s_add_u32 m0, s73, 16384
  s_nop 0
  buffer_load_dwordx4 v236, s[36:39], s71 offen lds
  s_mul_i32 s72, s70, 7168
  s_lshl_b32 s73, s70, 10
  s_add_u32 s71, s72, 143360
  s_add_u32 m0, s73, 20480
  s_nop 0
  buffer_load_dwordx4 v236, s[36:39], s71 offen lds
  s_mul_i32 s72, s70, 7168
  s_lshl_b32 s73, s70, 10
  s_add_u32 s71, s72, 172032
  s_add_u32 m0, s73, 24576
  s_nop 0
  buffer_load_dwordx4 v236, s[36:39], s71 offen lds
  s_mul_i32 s72, s70, 7168
  s_lshl_b32 s73, s70, 10
  s_add_u32 s71, s72, 200704
  s_add_u32 m0, s73, 28672
  s_nop 0
  buffer_load_dwordx4 v236, s[36:39], s71 offen lds
  s_mul_i32 s72, s70, 7168
  s_lshl_b32 s73, s70, 10
  s_add_u32 s71, s72, 229376
  s_add_u32 m0, s73, 32768
  s_nop 0
  buffer_load_dwordx4 v236, s[36:39], s71 offen lds
  s_mul_i32 s72, s70, 7168
  s_lshl_b32 s73, s70, 10
  s_add_u32 s71, s72, 258048
  s_add_u32 m0, s73, 36864
  s_nop 0
  buffer_load_dwordx4 v236, s[36:39], s71 offen lds
  s_mul_i32 s72, s70, 7168
  s_lshl_b32 s73, s70, 10
  s_add_u32 s71, s72, 286720
  s_add_u32 m0, s73, 40960
  s_nop 0
  buffer_load_dwordx4 v236, s[36:39], s71 offen lds
  s_mul_i32 s72, s70, 7168
  s_lshl_b32 s73, s70, 10
  s_add_u32 s71, s72, 315392
  s_add_u32 m0, s73, 45056
  s_nop 0
  buffer_load_dwordx4 v236, s[36:39], s71 offen lds
  s_mul_i32 s72, s70, 7168
  s_lshl_b32 s73, s70, 10
  s_add_u32 s71, s72, 344064
  s_add_u32 m0, s73, 49152
  s_nop 0
  buffer_load_dwordx4 v236, s[36:39], s71 offen lds
  s_mul_i32 s72, s70, 7168
  s_lshl_b32 s73, s70, 10
  s_add_u32 s71, s72, 372736
  s_add_u32 m0, s73, 53248
  s_nop 0
  buffer_load_dwordx4 v236, s[36:39], s71 offen lds
  s_mov_b32 s71, 401408
  s_mov_b32 m0, 57344
  s_nop 0
  buffer_load_dwordx4 v236, s[36:39], s71 offen lds
  s_sub_u32 s74, 3, s70
  s_mul_i32 s71, s74, 114688
  s_mul_i32 s72, s69, 224
  s_add_u32 s71, s71, s72
  s_mul_i32 s73, s74, 7168
  s_add_u32 m0, s73, 58368
  s_nop 0
  buffer_load_dwordx4 v224, s[40:43], s71 offen lds
  s_sub_u32 s74, 3, s70
  s_mul_i32 s71, s74, 114688
  s_mul_i32 s72, s69, 224
  s_add_u32 s71, s71, s72
  s_mul_i32 s73, s74, 7168
  s_add_u32 m0, s73, 59392
  s_nop 0
  buffer_load_dwordx4 v225, s[40:43], s71 offen lds
  s_sub_u32 s74, 3, s70
  s_mul_i32 s71, s74, 114688
  s_mul_i32 s72, s69, 224
  s_add_u32 s71, s71, s72
  s_mul_i32 s73, s74, 7168
  s_add_u32 m0, s73, 60416
  s_nop 0
  buffer_load_dwordx4 v226, s[40:43], s71 offen lds
  s_sub_u32 s74, 3, s70
  s_mul_i32 s71, s74, 114688
  s_mul_i32 s72, s69, 224
  s_add_u32 s71, s71, s72
  s_mul_i32 s73, s74, 7168
  s_add_u32 m0, s73, 61440
  s_nop 0
  buffer_load_dwordx4 v227, s[40:43], s71 offen lds
  s_sub_u32 s74, 3, s70
  s_mul_i32 s71, s74, 114688
  s_mul_i32 s72, s69, 224
  s_add_u32 s71, s71, s72
  s_mul_i32 s73, s74, 7168
  s_add_u32 m0, s73, 62464
  s_nop 0
  buffer_load_dwordx4 v228, s[40:43], s71 offen lds
  s_sub_u32 s74, 3, s70
  s_mul_i32 s71, s74, 114688
  s_mul_i32 s72, s69, 224
  s_add_u32 s71, s71, s72
  s_mul_i32 s73, s74, 7168
  s_add_u32 m0, s73, 63488
  s_nop 0
  buffer_load_dwordx4 v229, s[40:43], s71 offen lds
  s_sub_u32 s74, 3, s70
  s_mul_i32 s71, s74, 114688
  s_mul_i32 s72, s69, 224
  s_add_u32 s71, s71, s72
  s_mul_i32 s73, s74, 7168
  s_add_u32 m0, s73, 64512
  s_nop 0
  buffer_load_dwordx4 v230, s[40:43], s71 offen lds
  s_sub_u32 s74, 7, s70
  s_min_u32 s74, s74, 6
  s_mul_i32 s71, s74, 114688
  s_mul_i32 s72, s69, 224
  s_add_u32 s71, s71, s72
  s_mul_i32 s73, s74, 7168
  s_add_u32 m0, s73, 58368
  s_nop 0
  buffer_load_dwordx4 v224, s[40:43], s71 offen lds
  s_sub_u32 s74, 7, s70
  s_min_u32 s74, s74, 6
  s_mul_i32 s71, s74, 114688
  s_mul_i32 s72, s69, 224
  s_add_u32 s71, s71, s72
  s_mul_i32 s73, s74, 7168
  s_add_u32 m0, s73, 59392
  s_nop 0
  buffer_load_dwordx4 v225, s[40:43], s71 offen lds
  s_sub_u32 s74, 7, s70
  s_min_u32 s74, s74, 6
  s_mul_i32 s71, s74, 114688
  s_mul_i32 s72, s69, 224
  s_add_u32 s71, s71, s72
  s_mul_i32 s73, s74, 7168
  s_add_u32 m0, s73, 60416
  s_nop 0
  buffer_load_dwordx4 v226, s[40:43], s71 offen lds
  s_sub_u32 s74, 7, s70
  s_min_u32 s74, s74, 6
  s_mul_i32 s71, s74, 114688
  s_mul_i32 s72, s69, 224
  s_add_u32 s71, s71, s72
  s_mul_i32 s73, s74, 7168
  s_add_u32 m0, s73, 61440
  s_nop 0
  buffer_load_dwordx4 v227, s[40:43], s71 offen lds
  s_sub_u32 s74, 7, s70
  s_min_u32 s74, s74, 6
  s_mul_i32 s71, s74, 114688
  s_mul_i32 s72, s69, 224
  s_add_u32 s71, s71, s72
  s_mul_i32 s73, s74, 7168
  s_add_u32 m0, s73, 62464
  s_nop 0
  buffer_load_dwordx4 v228, s[40:43], s71 offen lds
  s_sub_u32 s74, 7, s70
  s_min_u32 s74, s74, 6
  s_mul_i32 s71, s74, 114688
  s_mul_i32 s72, s69, 224
  s_add_u32 s71, s71, s72
  s_mul_i32 s73, s74, 7168
  s_add_u32 m0, s73, 63488
  s_nop 0
  buffer_load_dwordx4 v229, s[40:43], s71 offen lds
  s_sub_u32 s74, 7, s70
  s_min_u32 s74, s74, 6
  s_mul_i32 s71, s74, 114688
  s_mul_i32 s72, s69, 224
  s_add_u32 s71, s71, s72
  s_mul_i32 s73, s74, 7168
  s_add_u32 m0, s73, 64512
  s_nop 0
  buffer_load_dwordx4 v230, s[40:43], s71 offen lds
  v_mov_b32 v208, 0xf149f2ca
  v_and_b32 v209, 31, v1
  v_lshrrev_b32 v210, 5, v1
  v_lshlrev_b32 v210, 2, v210
  v_sub_u32 v209, v209, v210
  s_mul_i32 s13, s70, 401408
  s_lshl_b32 s71, s92, 12
  s_add_u32 s13, s13, s71
  s_add_u32 s13, s13, 17825792
  v_cmp_ge_i32 s[14:15], v209, 0
  v_cmp_ge_i32 s[16:17], v209, 1
  v_cmp_ge_i32 s[18:19], v209, 2
  v_cmp_ge_i32 s[20:21], v209, 3
  v_cmp_ge_i32 s[22:23], v209, 8
  v_cmp_ge_i32 s[24:25], v209, 9
  v_cmp_ge_i32 s[26:27], v209, 10
  v_cmp_ge_i32 s[76:77], v209, 11
  v_cmp_ge_i32 s[78:79], v209, 16
  v_cmp_ge_i32 s[80:81], v209, 17
  v_cmp_ge_i32 s[82:83], v209, 18
  v_cmp_ge_i32 s[84:85], v209, 19
  v_cmp_ge_i32 s[86:87], v209, 24
  v_cmp_ge_i32 s[88:89], v209, 25
  v_cmp_ge_i32 s[10:11], v209, 26
  v_cmp_ge_i32 s[0:1], v209, 27
  v_mov_b32 v210, 0xffff
  v_mov_b32 v211, 0xffff0000
  v_cndmask_b32 v216, 0, v210, s[14:15]
  v_cndmask_b32 v214, 0, v211, s[16:17]
  v_or_b32 v216, v216, v214
  v_cndmask_b32 v217, 0, v210, s[18:19]
  v_cndmask_b32 v214, 0, v211, s[20:21]
  v_or_b32 v217, v217, v214
  v_cndmask_b32 v218, 0, v210, s[22:23]
  v_cndmask_b32 v214, 0, v211, s[24:25]
  v_or_b32 v218, v218, v214
  v_cndmask_b32 v219, 0, v210, s[26:27]
  v_cndmask_b32 v214, 0, v211, s[76:77]
  v_or_b32 v219, v219, v214
  v_cndmask_b32 v220, 0, v210, s[78:79]
  v_cndmask_b32 v214, 0, v211, s[80:81]
  v_or_b32 v220, v220, v214
  v_cndmask_b32 v221, 0, v210, s[82:83]
  v_cndmask_b32 v214, 0, v211, s[84:85]
  v_or_b32 v221, v221, v214
  v_cndmask_b32 v222, 0, v210, s[86:87]
  v_cndmask_b32 v214, 0, v211, s[88:89]
  v_or_b32 v222, v222, v214
  v_cndmask_b32 v223, 0, v210, s[10:11]
  v_cndmask_b32 v214, 0, v211, s[0:1]
  v_or_b32 v223, v223, v214
  s_mul_i32 s71, s70, 448
  s_add_u32 s71, s71, 16818176
  v_lshl_add_u32 v4, v1, 3, s71
  s_bfm_b64 exec, 56, 0
  s_mov_b32 s72, 0
Lpoll_35:
  buffer_load_dwordx2 v[2:3], v4, s[60:63], 0 offen sc1
  s_add_u32 s72, s72, 1
  s_cmp_gt_u32 s72, 0x40000
  s_cbranch_scc1 Lend
  s_waitcnt vmcnt(0)
  v_cmp_ne_u32 vcc, s4, v2
  v_cmp_ne_u32 s[96:97], s5, v3
  s_nop 2
  s_or_b64 vcc, vcc, s[96:97]
  s_cbranch_vccnz Lpoll_35
  s_mov_b64 exec, -1
  s_add_u32 s74, s13, 0
  buffer_load_dwordx4 a[0:3], v238, s[60:63], s74 offen offset:0 sc1
  s_add_u32 s74, s13, 0
  buffer_load_dwordx4 a[4:7], v238, s[60:63], s74 offen offset:1024 sc1
  s_add_u32 s74, s13, 0
  buffer_load_dwordx4 a[8:11], v238, s[60:63], s74 offen offset:2048 sc1
  s_add_u32 s74, s13, 0
  buffer_load_dwordx4 a[12:15], v238, s[60:63], s74 offen offset:3072 sc1
  s_add_u32 s74, s13, 28672
  buffer_load_dwordx4 a[16:19], v238, s[60:63], s74 offen offset:0 sc1
  s_add_u32 s74, s13, 28672
  buffer_load_dwordx4 a[20:23], v238, s[60:63], s74 offen offset:1024 sc1
  s_add_u32 s74, s13, 28672
  buffer_load_dwordx4 a[24:27], v238, s[60:63], s74 offen offset:2048 sc1
  s_add_u32 s74, s13, 28672
  buffer_load_dwordx4 a[28:31], v238, s[60:63], s74 offen offset:3072 sc1
  s_add_u32 s74, s13, 57344
  buffer_load_dwordx4 a[32:35], v238, s[60:63], s74 offen offset:0 sc1
  s_add_u32 s74, s13, 57344
  buffer_load_dwordx4 a[36:39], v238, s[60:63], s74 offen offset:1024 sc1
  s_cmp_eq_u32 s68, 0
  s_cbranch_scc1 LnoA_37
  s_lshl_b32 s71, s8, 5
  s_lshl_b32 s72, s70, 3
  s_add_u32 s71, s71, s72
  s_add_u32 s71, s71, 16776704
  s_min_u32 s72, s68, 2
  s_sub_u32 s72, s72, 1
  v_min_u32 v4, s72, v1
  v_mul_u32_u24 v4, 512, v4
  v_sub_u32 v4, s71, v4
  s_bfm_b64 exec, 2, 0
  s_mov_b32 s72, 0
Lpoll_38:
  buffer_load_dwordx2 v[2:3], v4, s[60:63], 0 offen sc1
  s_add_u32 s72, s72, 1
  s_cmp_gt_u32 s72, 0x40000
  s_cbranch_scc1 Lend
  s_waitcnt vmcnt(0)
  v_cmp_ne_u32 vcc, s4, v2
  v_cmp_ne_u32 s[96:97], s5, v3
  s_nop 2
  s_or_b64 vcc, vcc, s[96:97]
  s_cbranch_vccnz Lpoll_38
  s_mov_b64 exec, -1
LnoA_37:
  s_lshl_b32 s71, s70, 12
  s_add_u32 s71, s71, s94
  s_sub_u32 s72, s71, 524288
  s_cmp_lt_u32 s68, 2
  s_cselect_b32 s72, 0x7ffff000, s72
  buffer_load_dwordx4 v[16:19], v238, s[60:63], s72 offen offset:0 sc1
  buffer_load_dwordx4 v[20:23], v238, s[60:63], s72 offen offset:1024 sc1
  buffer_load_dwordx4 v[24:27], v238, s[60:63], s72 offen offset:2048 sc1
  buffer_load_dwordx4 v[28:31], v238, s[60:63], s72 offen offset:3072 sc1
  s_sub_u32 s72, s71, 262144
  s_cmp_lt_u32 s68, 1
  s_cselect_b32 s72, 0x7ffff000, s72
  buffer_load_dwordx4 v[32:35], v238, s[60:63], s72 offen offset:0 sc1
  buffer_load_dwordx4 v[36:39], v238, s[60:63], s72 offen offset:1024 sc1
  buffer_load_dwordx4 v[40:43], v238, s[60:63], s72 offen offset:2048 sc1
  buffer_load_dwordx4 v[44:47], v238, s[60:63], s72 offen offset:3072 sc1
  s_waitcnt vmcnt(4)
  ds_write_b128 v237, v[16:19] offset:0
  ds_write_b128 v237, v[20:23] offset:1024
  ds_write_b128 v237, v[24:27] offset:2048
  ds_write_b128 v237, v[28:31] offset:3072
  s_waitcnt vmcnt(0)
  ds_write_b128 v237, v[32:35] offset:16384
  ds_write_b128 v237, v[36:39] offset:17408
  ds_write_b128 v237, v[40:43] offset:18432
  ds_write_b128 v237, v[44:47] offset:19456
  s_waitcnt lgkmcnt(0)
  s_barrier
  s_lshr_b32 s71, s2, 3
  s_mul_i32 s71, s71, 56
  v_min_u32 v235, 55, v1
  v_add_u32 v235, s71, v235
  v_lshrrev_b32 v2, 7, v235
  v_and_b32 v235, 127, v235
  s_bfe_u32 s72, s2, 0x10002
  s_lshl_b32 s72, s72, 5
  s_sub_u32 s72, 127, s72
  v_min_u32 v235, s72, v235
  v_lshlrev_b32 v235, 7, v235
  v_mul_u32_u24 v2, 28672, v2
  v_add_u32 v235, v235, v2
  s_mul_i32 s71, s70, 401408
  s_bfe_u32 s72, s2, 0x10002
  s_lshl_b32 s72, s72, 14
  s_add_u32 s71, s71, s72
  s_add_u32 s71, s71, 17825792
  buffer_load_dword v239, v235, s[60:63], s71 offen sc1
  s_lshl_b32 s71, s68, 2
  s_add_u32 s9, s71, s70
  ds_read_b128 v[160:163], v237 offset:32768
  ds_read_b128 v[164:167], v237 offset:33792
  ds_read_b128 v[168:171], v237 offset:0
  ds_read_b128 v[172:175], v237 offset:1024
  s_waitcnt lgkmcnt(2)
  v_mfma_f32_32x32x16_bf16 v[144:159], v[160:163], v[240:243], 0
  v_mfma_f32_32x32x16_bf16 v[144:159], v[164:167], v[244:247], v[144:159]
  ds_read_b128 v[160:163], v237 offset:4096
  ds_read_b128 v[164:167], v237 offset:5120
  s_waitcnt lgkmcnt(2)
  v_mfma_f32_32x32x16_bf16 v[16:31], v[168:171], v[240:243], 0
  v_mfma_f32_32x32x16_bf16 v[16:31], v[172:175], v[244:247], v[16:31]
  ds_read_b128 v[168:171], v237 offset:8192
  ds_read_b128 v[172:175], v237 offset:9216
  s_waitcnt lgkmcnt(2)
  v_mfma_f32_32x32x16_bf16 v[32:47], v[160:163], v[240:243], 0
  v_mfma_f32_32x32x16_bf16 v[32:47], v[164:167], v[244:247], v[32:47]
  s_cmp_ge_u32 s9, 8
  s_cbranch_scc1 Linv_40
  s_nop 4
  v_mov_b32 v16, v208
  v_mov_b32 v17, v208
  v_mov_b32 v18, v208
  v_mov_b32 v19, v208
  v_mov_b32 v20, v208
  v_mov_b32 v21, v208
  v_mov_b32 v22, v208
  v_mov_b32 v23, v208
  v_mov_b32 v24, v208
  v_mov_b32 v25, v208
  v_mov_b32 v26, v208
  v_mov_b32 v27, v208
  v_mov_b32 v28, v208
  v_mov_b32 v29, v208
  v_mov_b32 v30, v208
  v_mov_b32 v31, v208
Linv_40:
  s_nop 4
  v_cndmask_b32 v16, v16, v144, s[14:15]
  v_cndmask_b32 v17, v17, v145, s[16:17]
  v_cndmask_b32 v18, v18, v146, s[18:19]
  v_cndmask_b32 v19, v19, v147, s[20:21]
  v_cndmask_b32 v20, v20, v148, s[22:23]
  v_cndmask_b32 v21, v21, v149, s[24:25]
  v_cndmask_b32 v22, v22, v150, s[26:27]
  v_cndmask_b32 v23, v23, v151, s[76:77]
  v_cndmask_b32 v24, v24, v152, s[78:79]
  v_cndmask_b32 v25, v25, v153, s[80:81]
  v_cndmask_b32 v26, v26, v154, s[82:83]
  v_cndmask_b32 v27, v27, v155, s[84:85]
  v_cndmask_b32 v28, v28, v156, s[86:87]
  v_cndmask_b32 v29, v29, v157, s[88:89]
  v_cndmask_b32 v30, v30, v158, s[10:11]
  v_cndmask_b32 v31, v31, v159, s[0:1]
  v_max_f32 v210, v16, v17
  v_max_f32 v211, v18, v19
  v_max3_f32 v210, v210, v20, v21
  v_max3_f32 v211, v211, v22, v23
  v_max3_f32 v210, v210, v24, v25
  v_max3_f32 v211, v211, v26, v27
  v_max3_f32 v210, v210, v28, v29
  v_max3_f32 v211, v211, v30, v31
  ds_read_b128 v[160:163], v237 offset:12288
  ds_read_b128 v[164:167], v237 offset:13312
  s_waitcnt lgkmcnt(2)
  v_mfma_f32_32x32x16_bf16 v[48:63], v[168:171], v[240:243], 0
  v_mfma_f32_32x32x16_bf16 v[48:63], v[172:175], v[244:247], v[48:63]
  s_cmp_ge_u32 s9, 7
  s_cbranch_scc1 Linv_41
  v_mov_b32 v32, v208
  v_mov_b32 v33, v208
  v_mov_b32 v34, v208
  v_mov_b32 v35, v208
  v_mov_b32 v36, v208
  v_mov_b32 v37, v208
  v_mov_b32 v38, v208
  v_mov_b32 v39, v208
  v_mov_b32 v40, v208
  v_mov_b32 v41, v208
  v_mov_b32 v42, v208
  v_mov_b32 v43, v208
  v_mov_b32 v44, v208
  v_mov_b32 v45, v208
  v_mov_b32 v46, v208
  v_mov_b32 v47, v208
Linv_41:
  v_max3_f32 v210, v210, v32, v33
  v_max3_f32 v211, v211, v34, v35
  v_max3_f32 v210, v210, v36, v37
  v_max3_f32 v211, v211, v38, v39
  v_max3_f32 v210, v210, v40, v41
  v_max3_f32 v211, v211, v42, v43
  v_max3_f32 v210, v210, v44, v45
  v_max3_f32 v211, v211, v46, v47
  ds_read_b128 v[168:171], v237 offset:16384
  ds_read_b128 v[172:175], v237 offset:17408
  s_waitcnt lgkmcnt(2)
  v_mfma_f32_32x32x16_bf16 v[64:79], v[160:163], v[240:243], 0
  v_mfma_f32_32x32x16_bf16 v[64:79], v[164:167], v[244:247], v[64:79]
  s_cmp_ge_u32 s9, 6
  s_cbranch_scc1 Linv_42
  v_mov_b32 v48, v208
  v_mov_b32 v49, v208
  v_mov_b32 v50, v208
  v_mov_b32 v51, v208
  v_mov_b32 v52, v208
  v_mov_b32 v53, v208
  v_mov_b32 v54, v208
  v_mov_b32 v55, v208
  v_mov_b32 v56, v208
  v_mov_b32 v57, v208
  v_mov_b32 v58, v208
  v_mov_b32 v59, v208
  v_mov_b32 v60, v208
  v_mov_b32 v61, v208
  v_mov_b32 v62, v208
  v_mov_b32 v63, v208
Linv_42:
  v_max3_f32 v210, v210, v48, v49
  v_max3_f32 v211, v211, v50, v51
  v_max3_f32 v210, v210, v52, v53
  v_max3_f32 v211, v211, v54, v55
  v_max3_f32 v210, v210, v56, v57
  v_max3_f32 v211, v211, v58, v59
  v_max3_f32 v210, v210, v60, v61
  v_max3_f32 v211, v211, v62, v63
  ds_read_b128 v[160:163], v237 offset:20480
  ds_read_b128 v[164:167], v237 offset:21504
  s_waitcnt lgkmcnt(2)
  v_mfma_f32_32x32x16_bf16 v[80:95], v[168:171], v[240:243], 0
  v_mfma_f32_32x32x16_bf16 v[80:95], v[172:175], v[244:247], v[80:95]
  s_cmp_ge_u32 s9, 5
  s_cbranch_scc1 Linv_43
  v_mov_b32 v64, v208
  v_mov_b32 v65, v208
  v_mov_b32 v66, v208
  v_mov_b32 v67, v208
  v_mov_b32 v68, v208
  v_mov_b32 v69, v208
  v_mov_b32 v70, v208
  v_mov_b32 v71, v208
  v_mov_b32 v72, v208
  v_mov_b32 v73, v208
  v_mov_b32 v74, v208
  v_mov_b32 v75, v208
  v_mov_b32 v76, v208
  v_mov_b32 v77, v208
  v_mov_b32 v78, v208
  v_mov_b32 v79, v208
Linv_43:
  v_max3_f32 v210, v210, v64, v65
  v_max3_f32 v211, v211, v66, v67
  v_max3_f32 v210, v210, v68, v69
  v_max3_f32 v211, v211, v70, v71
  v_max3_f32 v210, v210, v72, v73
  v_max3_f32 v211, v211, v74, v75
  v_max3_f32 v210, v210, v76, v77
  v_max3_f32 v211, v211, v78, v79
  ds_read_b128 v[168:171], v237 offset:24576
  ds_read_b128 v[172:175], v237 offset:25600
  s_waitcnt lgkmcnt(2)
  v_mfma_f32_32x32x16_bf16 v[96:111], v[160:163], v[240:243], 0
  v_mfma_f32_32x32x16_bf16 v[96:111], v[164:167], v[244:247], v[96:111]
  s_cmp_ge_u32 s9, 4
  s_cbranch_scc1 Linv_44
  v_mov_b32 v80, v208
  v_mov_b32 v81, v208
  v_mov_b32 v82, v208
  v_mov_b32 v83, v208
  v_mov_b32 v84, v208
  v_mov_b32 v85, v208
  v_mov_b32 v86, v208
  v_mov_b32 v87, v208
  v_mov_b32 v88, v208
  v_mov_b32 v89, v208
  v_mov_b32 v90, v208
  v_mov_b32 v91, v208
  v_mov_b32 v92, v208
  v_mov_b32 v93, v208
  v_mov_b32 v94, v208
  v_mov_b32 v95, v208
Linv_44:
  v_max3_f32 v210, v210, v80, v81
  v_max3_f32 v211, v211, v82, v83
  v_max3_f32 v210, v210, v84, v85
  v_max3_f32 v211, v211, v86, v87
  v_max3_f32 v210, v210, v88, v89
  v_max3_f32 v211, v211, v90, v91
  v_max3_f32 v210, v210, v92, v93
  v_max3_f32 v211, v211, v94, v95
  ds_read_b128 v[160:163], v237 offset:28672
  ds_read_b128 v[164:167], v237 offset:29696
  s_waitcnt lgkmcnt(2)
  v_mfma_f32_32x32x16_bf16 v[112:127], v[168:171], v[240:243], 0
  v_mfma_f32_32x32x16_bf16 v[112:127], v[172:175], v[244:247], v[112:127]
  s_cmp_ge_u32 s9, 3
  s_cbranch_scc1 Linv_45
  v_mov_b32 v96, v208
  v_mov_b32 v97, v208
  v_mov_b32 v98, v208
  v_mov_b32 v99, v208
  v_mov_b32 v100, v208
  v_mov_b32 v101, v208
  v_mov_b32 v102, v208
  v_mov_b32 v103, v208
  v_mov_b32 v104, v208
  v_mov_b32 v105, v208
  v_mov_b32 v106, v208
  v_mov_b32 v107, v208
  v_mov_b32 v108, v208
  v_mov_b32 v109, v208
  v_mov_b32 v110, v208
  v_mov_b32 v111, v208
Linv_45:
  v_max3_f32 v210, v210, v96, v97
  v_max3_f32 v211, v211, v98, v99
  v_max3_f32 v210, v210, v100, v101
  v_max3_f32 v211, v211, v102, v103
  v_max3_f32 v210, v210, v104, v105
  v_max3_f32 v211, v211, v106, v107
  v_max3_f32 v210, v210, v108, v109
  v_max3_f32 v211, v211, v110, v111
  s_waitcnt lgkmcnt(0)
  v_mfma_f32_32x32x16_bf16 v[128:143], v[160:163], v[240:243], 0
  v_mfma_f32_32x32x16_bf16 v[128:143], v[164:167], v[244:247], v[128:143]
  s_cmp_ge_u32 s9, 2
  s_cbranch_scc1 Linv_46
  v_mov_b32 v112, v208
  v_mov_b32 v113, v208
  v_mov_b32 v114, v208
  v_mov_b32 v115, v208
  v_mov_b32 v116, v208
  v_mov_b32 v117, v208
  v_mov_b32 v118, v208
  v_mov_b32 v119, v208
  v_mov_b32 v120, v208
  v_mov_b32 v121, v208
  v_mov_b32 v122, v208
  v_mov_b32 v123, v208
  v_mov_b32 v124, v208
  v_mov_b32 v125, v208
  v_mov_b32 v126, v208
  v_mov_b32 v127, v208
Linv_46:
  v_max3_f32 v210, v210, v112, v113
  v_max3_f32 v211, v211, v114, v115
  v_max3_f32 v210, v210, v116, v117
  v_max3_f32 v211, v211, v118, v119
  v_max3_f32 v210, v210, v120, v121
  v_max3_f32 v211, v211, v122, v123
  v_max3_f32 v210, v210, v124, v125
  v_max3_f32 v211, v211, v126, v127
  s_cmp_ge_u32 s9, 1
  s_cbranch_scc1 Linv_47
  v_mov_b32 v128, v208
  v_mov_b32 v129, v208
  v_mov_b32 v130, v208
  v_mov_b32 v131, v208
  v_mov_b32 v132, v208
  v_mov_b32 v133, v208
  v_mov_b32 v134, v208
  v_mov_b32 v135, v208
  v_mov_b32 v136, v208
  v_mov_b32 v137, v208
  v_mov_b32 v138, v208
  v_mov_b32 v139, v208
  v_mov_b32 v140, v208
  v_mov_b32 v141, v208
  v_mov_b32 v142, v208
  v_mov_b32 v143, v208
Linv_47:
  v_max3_f32 v210, v210, v128, v129
  v_max3_f32 v211, v211, v130, v131
  v_max3_f32 v210, v210, v132, v133
  v_max3_f32 v211, v211, v134, v135
  v_max3_f32 v210, v210, v136, v137
  v_max3_f32 v211, v211, v138, v139
  v_max3_f32 v210, v210, v140, v141
  v_max3_f32 v211, v211, v142, v143
  v_max_f32 v210, v210, v211
  v_mov_b32 v211, v210
  s_nop 1
  v_permlane32_swap_b32 v210, v211
  v_max_f32 v210, v210, v211
  v_sub_f32 v214, 0, v210
  v_sub_f32 v215, 0, v210
  ds_read_b128 v[176:179], v237 offset:6144
  ds_read_b128 v[180:183], v237 offset:7168
  ds_read_b128 v[184:187], v237 offset:10240
  ds_read_b128 v[188:191], v237 offset:11264
  v_pk_add_f32 v[32:33], v[32:33], v[214:215]
  v_pk_add_f32 v[34:35], v[34:35], v[214:215]
  v_pk_add_f32 v[36:37], v[36:37], v[214:215]
  v_pk_add_f32 v[38:39], v[38:39], v[214:215]
  v_pk_add_f32 v[40:41], v[40:41], v[214:215]
  v_pk_add_f32 v[42:43], v[42:43], v[214:215]
  v_pk_add_f32 v[44:45], v[44:45], v[214:215]
  v_pk_add_f32 v[46:47], v[46:47], v[214:215]
  v_exp_f32 v32, v32
  v_exp_f32 v33, v33
  v_exp_f32 v34, v34
  v_exp_f32 v35, v35
  v_exp_f32 v36, v36
  v_exp_f32 v37, v37
  s_add_u32 s74, s13, 57344
  buffer_load_dwordx4 a[40:43], v238, s[60:63], s74 offen offset:2048 sc1
  v_exp_f32 v38, v38
  v_exp_f32 v39, v39
  v_exp_f32 v40, v40
  v_exp_f32 v41, v41
  v_exp_f32 v42, v42
  v_exp_f32 v43, v43
  s_add_u32 s74, s13, 57344
  buffer_load_dwordx4 a[44:47], v238, s[60:63], s74 offen offset:3072 sc1
  v_exp_f32 v44, v44
  v_exp_f32 v45, v45
  v_exp_f32 v46, v46
  v_exp_f32 v47, v47
  v_cvt_pk_bf16_f32 v32, v32, v33
  v_cvt_pk_bf16_f32 v33, v34, v35
  v_cvt_pk_bf16_f32 v34, v36, v37
  v_cvt_pk_bf16_f32 v35, v38, v39
  v_cvt_pk_bf16_f32 v36, v40, v41
  v_cvt_pk_bf16_f32 v37, v42, v43
  v_cvt_pk_bf16_f32 v38, v44, v45
  v_cvt_pk_bf16_f32 v39, v46, v47
  s_waitcnt lgkmcnt(2)
  v_mfma_f32_32x32x16_bf16 v[192:207], v[176:179], v[32:35], 0
  v_mfma_f32_32x32x16_bf16 v[192:207], v[180:183], v[36:39], v[192:207]
  ds_read_b128 v[176:179], v237 offset:14336
  ds_read_b128 v[180:183], v237 offset:15360
  v_pk_add_f32 v[48:49], v[48:49], v[214:215]
  v_pk_add_f32 v[50:51], v[50:51], v[214:215]
  v_pk_add_f32 v[52:53], v[52:53], v[214:215]
  v_pk_add_f32 v[54:55], v[54:55], v[214:215]
  v_pk_add_f32 v[56:57], v[56:57], v[214:215]
  v_pk_add_f32 v[58:59], v[58:59], v[214:215]
  v_pk_add_f32 v[60:61], v[60:61], v[214:215]
  v_pk_add_f32 v[62:63], v[62:63], v[214:215]
  v_exp_f32 v48, v48
  v_exp_f32 v49, v49
  v_exp_f32 v50, v50
  v_exp_f32 v51, v51
  v_exp_f32 v52, v52
  v_exp_f32 v53, v53
  s_add_u32 s74, s13, 86016
  buffer_load_dwordx4 a[48:51], v238, s[60:63], s74 offen offset:0 sc1
  v_exp_f32 v54, v54
  v_exp_f32 v55, v55
  v_exp_f32 v56, v56
  v_exp_f32 v57, v57
  v_exp_f32 v58, v58
  v_exp_f32 v59, v59
  s_add_u32 s74, s13, 86016
  buffer_load_dwordx4 a[52:55], v238, s[60:63], s74 offen offset:1024 sc1
  v_exp_f32 v60, v60
  v_exp_f32 v61, v61
  v_exp_f32 v62, v62
  v_exp_f32 v63, v63
  v_cvt_pk_bf16_f32 v48, v48, v49
  v_cvt_pk_bf16_f32 v49, v50, v51
  v_cvt_pk_bf16_f32 v50, v52, v53
  v_cvt_pk_bf16_f32 v51, v54, v55
  v_cvt_pk_bf16_f32 v52, v56, v57
  v_cvt_pk_bf16_f32 v53, v58, v59
  v_cvt_pk_bf16_f32 v54, v60, v61
  v_cvt_pk_bf16_f32 v55, v62, v63
  s_waitcnt lgkmcnt(2)
  v_mfma_f32_32x32x16_bf16 v[192:207], v[184:187], v[48:51], v[192:207]
  v_mfma_f32_32x32x16_bf16 v[192:207], v[188:191], v[52:55], v[192:207]
  ds_read_b128 v[184:187], v237 offset:18432
  ds_read_b128 v[188:191], v237 offset:19456
  v_pk_add_f32 v[64:65], v[64:65], v[214:215]
  v_pk_add_f32 v[66:67], v[66:67], v[214:215]
  v_pk_add_f32 v[68:69], v[68:69], v[214:215]
  v_pk_add_f32 v[70:71], v[70:71], v[214:215]
  v_pk_add_f32 v[72:73], v[72:73], v[214:215]
  v_pk_add_f32 v[74:75], v[74:75], v[214:215]
  v_pk_add_f32 v[76:77], v[76:77], v[214:215]
  v_pk_add_f32 v[78:79], v[78:79], v[214:215]
  v_exp_f32 v64, v64
  v_exp_f32 v65, v65
  v_exp_f32 v66, v66
  v_exp_f32 v67, v67
  v_exp_f32 v68, v68
  v_exp_f32 v69, v69
  s_add_u32 s74, s13, 86016
  buffer_load_dwordx4 a[56:59], v238, s[60:63], s74 offen offset:2048 sc1
  v_exp_f32 v70, v70
  v_exp_f32 v71, v71
  v_exp_f32 v72, v72
  v_exp_f32 v73, v73
  v_exp_f32 v74, v74
  v_exp_f32 v75, v75
  s_add_u32 s74, s13, 86016
  buffer_load_dwordx4 a[60:63], v238, s[60:63], s74 offen offset:3072 sc1
  v_exp_f32 v76, v76
  v_exp_f32 v77, v77
  v_exp_f32 v78, v78
  v_exp_f32 v79, v79
  v_cvt_pk_bf16_f32 v64, v64, v65
  v_cvt_pk_bf16_f32 v65, v66, v67
  v_cvt_pk_bf16_f32 v66, v68, v69
  v_cvt_pk_bf16_f32 v67, v70, v71
  v_cvt_pk_bf16_f32 v68, v72, v73
  v_cvt_pk_bf16_f32 v69, v74, v75
  v_cvt_pk_bf16_f32 v70, v76, v77
  v_cvt_pk_bf16_f32 v71, v78, v79
  s_waitcnt lgkmcnt(2)
  v_mfma_f32_32x32x16_bf16 v[192:207], v[176:179], v[64:67], v[192:207]
  v_mfma_f32_32x32x16_bf16 v[192:207], v[180:183], v[68:71], v[192:207]
  ds_read_b128 v[176:179], v237 offset:22528
  ds_read_b128 v[180:183], v237 offset:23552
  v_pk_add_f32 v[80:81], v[80:81], v[214:215]
  v_pk_add_f32 v[82:83], v[82:83], v[214:215]
  v_pk_add_f32 v[84:85], v[84:85], v[214:215]
  v_pk_add_f32 v[86:87], v[86:87], v[214:215]
  v_pk_add_f32 v[88:89], v[88:89], v[214:215]
  v_pk_add_f32 v[90:91], v[90:91], v[214:215]
  v_pk_add_f32 v[92:93], v[92:93], v[214:215]
  v_pk_add_f32 v[94:95], v[94:95], v[214:215]
  v_exp_f32 v80, v80
  v_exp_f32 v81, v81
  v_exp_f32 v82, v82
  v_exp_f32 v83, v83
  v_exp_f32 v84, v84
  v_exp_f32 v85, v85
  s_add_u32 s74, s13, 114688
  buffer_load_dwordx4 a[64:67], v238, s[60:63], s74 offen offset:0 sc1
  v_exp_f32 v86, v86
  v_exp_f32 v87, v87
  v_exp_f32 v88, v88
  v_exp_f32 v89, v89
  v_exp_f32 v90, v90
  v_exp_f32 v91, v91
  s_add_u32 s74, s13, 114688
  buffer_load_dwordx4 a[68:71], v238, s[60:63], s74 offen offset:1024 sc1
  v_exp_f32 v92, v92
  v_exp_f32 v93, v93
  v_exp_f32 v94, v94
  v_exp_f32 v95, v95
  v_cvt_pk_bf16_f32 v80, v80, v81
  v_cvt_pk_bf16_f32 v81, v82, v83
  v_cvt_pk_bf16_f32 v82, v84, v85
  v_cvt_pk_bf16_f32 v83, v86, v87
  v_cvt_pk_bf16_f32 v84, v88, v89
  v_cvt_pk_bf16_f32 v85, v90, v91
  v_cvt_pk_bf16_f32 v86, v92, v93
  v_cvt_pk_bf16_f32 v87, v94, v95
  s_waitcnt lgkmcnt(2)
  v_mfma_f32_32x32x16_bf16 v[192:207], v[184:187], v[80:83], v[192:207]
  v_mfma_f32_32x32x16_bf16 v[192:207], v[188:191], v[84:87], v[192:207]
  ds_read_b128 v[184:187], v237 offset:26624
  ds_read_b128 v[188:191], v237 offset:27648
  v_pk_add_f32 v[96:97], v[96:97], v[214:215]
  v_pk_add_f32 v[98:99], v[98:99], v[214:215]
  v_pk_add_f32 v[100:101], v[100:101], v[214:215]
  v_pk_add_f32 v[102:103], v[102:103], v[214:215]
  v_pk_add_f32 v[104:105], v[104:105], v[214:215]
  v_pk_add_f32 v[106:107], v[106:107], v[214:215]
  v_pk_add_f32 v[108:109], v[108:109], v[214:215]
  v_pk_add_f32 v[110:111], v[110:111], v[214:215]
  v_exp_f32 v96, v96
  v_exp_f32 v97, v97
  v_exp_f32 v98, v98
  v_exp_f32 v99, v99
  v_exp_f32 v100, v100
  v_exp_f32 v101, v101
  s_add_u32 s74, s13, 114688
  buffer_load_dwordx4 a[72:75], v238, s[60:63], s74 offen offset:2048 sc1
  v_exp_f32 v102, v102
  v_exp_f32 v103, v103
  v_exp_f32 v104, v104
  v_exp_f32 v105, v105
  v_exp_f32 v106, v106
  v_exp_f32 v107, v107
  s_add_u32 s74, s13, 114688
  buffer_load_dwordx4 a[76:79], v238, s[60:63], s74 offen offset:3072 sc1
  v_exp_f32 v108, v108
  v_exp_f32 v109, v109
  v_exp_f32 v110, v110
  v_exp_f32 v111, v111
  v_cvt_pk_bf16_f32 v96, v96, v97
  v_cvt_pk_bf16_f32 v97, v98, v99
  v_cvt_pk_bf16_f32 v98, v100, v101
  v_cvt_pk_bf16_f32 v99, v102, v103
  v_cvt_pk_bf16_f32 v100, v104, v105
  v_cvt_pk_bf16_f32 v101, v106, v107
  v_cvt_pk_bf16_f32 v102, v108, v109
  v_cvt_pk_bf16_f32 v103, v110, v111
  s_waitcnt lgkmcnt(2)
  v_mfma_f32_32x32x16_bf16 v[192:207], v[176:179], v[96:99], v[192:207]
  v_mfma_f32_32x32x16_bf16 v[192:207], v[180:183], v[100:103], v[192:207]
  ds_read_b128 v[176:179], v237 offset:30720
  ds_read_b128 v[180:183], v237 offset:31744
  v_pk_add_f32 v[112:113], v[112:113], v[214:215]
  v_pk_add_f32 v[114:115], v[114:115], v[214:215]
  v_pk_add_f32 v[116:117], v[116:117], v[214:215]
  v_pk_add_f32 v[118:119], v[118:119], v[214:215]
  v_pk_add_f32 v[120:121], v[120:121], v[214:215]
  v_pk_add_f32 v[122:123], v[122:123], v[214:215]
  v_pk_add_f32 v[124:125], v[124:125], v[214:215]
  v_pk_add_f32 v[126:127], v[126:127], v[214:215]
  v_exp_f32 v112, v112
  v_exp_f32 v113, v113
  v_exp_f32 v114, v114
  v_exp_f32 v115, v115
  v_exp_f32 v116, v116
  v_exp_f32 v117, v117
  s_add_u32 s74, s13, 143360
  buffer_load_dwordx4 a[80:83], v238, s[60:63], s74 offen offset:0 sc1
  v_exp_f32 v118, v118
  v_exp_f32 v119, v119
  v_exp_f32 v120, v120
  v_exp_f32 v121, v121
  v_exp_f32 v122, v122
  v_exp_f32 v123, v123
  s_add_u32 s74, s13, 143360
  buffer_load_dwordx4 a[84:87], v238, s[60:63], s74 offen offset:1024 sc1
  v_exp_f32 v124, v124
  v_exp_f32 v125, v125
  v_exp_f32 v126, v126
  v_exp_f32 v127, v127
  v_cvt_pk_bf16_f32 v112, v112, v113
  v_cvt_pk_bf16_f32 v113, v114, v115
  v_cvt_pk_bf16_f32 v114, v116, v117
  v_cvt_pk_bf16_f32 v115, v118, v119
  v_cvt_pk_bf16_f32 v116, v120, v121
  v_cvt_pk_bf16_f32 v117, v122, v123
  v_cvt_pk_bf16_f32 v118, v124, v125
  v_cvt_pk_bf16_f32 v119, v126, v127
  s_waitcnt lgkmcnt(2)
  v_mfma_f32_32x32x16_bf16 v[192:207], v[184:187], v[112:115], v[192:207]
  v_mfma_f32_32x32x16_bf16 v[192:207], v[188:191], v[116:119], v[192:207]
  ds_read_b128 v[184:187], v237 offset:2048
  ds_read_b128 v[188:191], v237 offset:3072
  v_pk_add_f32 v[128:129], v[128:129], v[214:215]
  v_pk_add_f32 v[130:131], v[130:131], v[214:215]
  v_pk_add_f32 v[132:133], v[132:133], v[214:215]
  v_pk_add_f32 v[134:135], v[134:135], v[214:215]
  v_pk_add_f32 v[136:137], v[136:137], v[214:215]
  v_pk_add_f32 v[138:139], v[138:139], v[214:215]
  v_pk_add_f32 v[140:141], v[140:141], v[214:215]
  v_pk_add_f32 v[142:143], v[142:143], v[214:215]
  v_exp_f32 v128, v128
  v_exp_f32 v129, v129
  v_exp_f32 v130, v130
  v_exp_f32 v131, v131
  v_exp_f32 v132, v132
  v_exp_f32 v133, v133
  s_add_u32 s74, s13, 143360
  buffer_load_dwordx4 a[88:91], v238, s[60:63], s74 offen offset:2048 sc1
  v_exp_f32 v134, v134
  v_exp_f32 v135, v135
  v_exp_f32 v136, v136
  v_exp_f32 v137, v137
  v_exp_f32 v138, v138
  v_exp_f32 v139, v139
  s_add_u32 s74, s13, 143360
  buffer_load_dwordx4 a[92:95], v238, s[60:63], s74 offen offset:3072 sc1
  v_exp_f32 v140, v140
  v_exp_f32 v141, v141
  v_exp_f32 v142, v142
  v_exp_f32 v143, v143
  v_cvt_pk_bf16_f32 v128, v128, v129
  v_cvt_pk_bf16_f32 v129, v130, v131
  v_cvt_pk_bf16_f32 v130, v132, v133
  v_cvt_pk_bf16_f32 v131, v134, v135
  v_cvt_pk_bf16_f32 v132, v136, v137
  v_cvt_pk_bf16_f32 v133, v138, v139
  v_cvt_pk_bf16_f32 v134, v140, v141
  v_cvt_pk_bf16_f32 v135, v142, v143
  s_waitcnt lgkmcnt(2)
  v_mfma_f32_32x32x16_bf16 v[192:207], v[176:179], v[128:131], v[192:207]
  v_mfma_f32_32x32x16_bf16 v[192:207], v[180:183], v[132:135], v[192:207]
  ds_read_b128 v[176:179], v237 offset:34816
  ds_read_b128 v[180:183], v237 offset:35840
  v_pk_add_f32 v[16:17], v[16:17], v[214:215]
  v_pk_add_f32 v[18:19], v[18:19], v[214:215]
  v_pk_add_f32 v[20:21], v[20:21], v[214:215]
  v_pk_add_f32 v[22:23], v[22:23], v[214:215]
  v_pk_add_f32 v[24:25], v[24:25], v[214:215]
  v_pk_add_f32 v[26:27], v[26:27], v[214:215]
  v_pk_add_f32 v[28:29], v[28:29], v[214:215]
  v_pk_add_f32 v[30:31], v[30:31], v[214:215]
  v_exp_f32 v16, v16
  v_exp_f32 v17, v17
  v_exp_f32 v18, v18
  v_exp_f32 v19, v19
  v_exp_f32 v20, v20
  v_exp_f32 v21, v21
  s_add_u32 s74, s13, 172032
  buffer_load_dwordx4 a[96:99], v238, s[60:63], s74 offen offset:0 sc1
  v_exp_f32 v22, v22
  v_exp_f32 v23, v23
  v_exp_f32 v24, v24
  v_exp_f32 v25, v25
  v_exp_f32 v26, v26
  v_exp_f32 v27, v27
  s_add_u32 s74, s13, 172032
  buffer_load_dwordx4 a[100:103], v238, s[60:63], s74 offen offset:1024 sc1
  v_exp_f32 v28, v28
  v_exp_f32 v29, v29
  v_exp_f32 v30, v30
  v_exp_f32 v31, v31
  v_cvt_pk_bf16_f32 v16, v16, v17
  v_cvt_pk_bf16_f32 v17, v18, v19
  v_cvt_pk_bf16_f32 v18, v20, v21
  v_cvt_pk_bf16_f32 v19, v22, v23
  v_cvt_pk_bf16_f32 v20, v24, v25
  v_cvt_pk_bf16_f32 v21, v26, v27
  v_cvt_pk_bf16_f32 v22, v28, v29
  v_cvt_pk_bf16_f32 v23, v30, v31
  v_and_b32 v144, v16, v216
  v_bfi_b32 v16, v216, 0, v16
  v_and_b32 v145, v17, v217
  v_bfi_b32 v17, v217, 0, v17
  v_and_b32 v146, v18, v218
  v_bfi_b32 v18, v218, 0, v18
  v_and_b32 v147, v19, v219
  v_bfi_b32 v19, v219, 0, v19
  v_and_b32 v148, v20, v220
  v_bfi_b32 v20, v220, 0, v20
  v_and_b32 v149, v21, v221
  v_bfi_b32 v21, v221, 0, v21
  v_and_b32 v150, v22, v222
  v_bfi_b32 v22, v222, 0, v22
  v_and_b32 v151, v23, v223
  v_bfi_b32 v23, v223, 0, v23
  s_waitcnt lgkmcnt(2)
  v_mfma_f32_32x32x16_bf16 v[192:207], v[184:187], v[16:19], v[192:207]
  v_mfma_f32_32x32x16_bf16 v[192:207], v[188:191], v[20:23], v[192:207]
  s_waitcnt lgkmcnt(0)
  v_mfma_f32_32x32x16_bf16 v[192:207], v[176:179], v[144:147], v[192:207]
  v_mfma_f32_32x32x16_bf16 v[192:207], v[180:183], v[148:151], v[192:207]
  s_lshl_b32 s71, s68, 3
  s_lshl_b32 s72, s70, 1
  s_add_u32 s71, s71, s72
  s_lshl_b32 s71, s71, 4
  s_add_u32 s71, s71, s69
  s_lshl_b32 s71, s71, 10
  s_add_u32 s74, s71, 0
  v_bfe_u32 v214, v1, 4, 1
  v_lshlrev_b32 v214, 14, v214
  v_and_b32 v213, 15, v1
  v_lshl_add_u32 v214, v213, 4, v214
  v_lshrrev_b32 v213, 5, v1
  v_lshl_add_u32 v214, v213, 8, v214
  v_mov_b32 v212, v204
  v_mov_b32 v213, v204
  s_nop 1
  v_permlane32_swap_b32 v212, v213
  v_rcp_f32 v213, v213
  s_nop 0
  v_mul_f32 v192, v192, v213
  v_mul_f32 v193, v193, v213
  v_mul_f32 v194, v194, v213
  v_mul_f32 v195, v195, v213
  v_mul_f32 v196, v196, v213
  v_mul_f32 v197, v197, v213
  v_mul_f32 v198, v198, v213
  v_mul_f32 v199, v199, v213
  v_mul_f32 v200, v200, v213
  v_mul_f32 v201, v201, v213
  v_mul_f32 v202, v202, v213
  v_mul_f32 v203, v203, v213
  v_mul_f32 v204, v204, v213
  v_mul_f32 v205, v205, v213
  v_mul_f32 v206, v206, v213
  v_mul_f32 v207, v207, v213
  v_cvt_pk_bf16_f32 v192, v192, v193
  v_cvt_pk_bf16_f32 v193, v194, v195
  v_cvt_pk_bf16_f32 v194, v196, v197
  v_cvt_pk_bf16_f32 v195, v198, v199
  v_cvt_pk_bf16_f32 v196, v200, v201
  v_cvt_pk_bf16_f32 v197, v202, v203
  v_cvt_pk_bf16_f32 v198, v204, v205
  v_cvt_pk_bf16_f32 v199, v206, v207
  v_cndmask_b32 v198, v198, 0, s[6:7]
  v_cndmask_b32 v199, v199, 0, s[6:7]
  buffer_store_dwordx4 v[192:195], v214, s[60:63], s74 offen sc1
  buffer_store_dwordx4 v[196:199], v214, s[60:63], s74 offen offset:512 sc1
  s_lshl_b32 s76, s68, 3
  s_lshl_b32 s71, s93, 2
  s_add_u32 s76, s76, s71
  s_add_u32 s76, s76, s70
  v_and_b32 v11, 15, v1
  s_lshl_b32 s71, s76, 4
  v_add_u32 v11, s71, v11
  v_mul_u32_u24 v12, 896, v11
  v_lshl_add_u32 v12, v231, 3, v12
  buffer_load_dwordx2 v[144:145], v12, s[28:31], s91 offen offset:0
  buffer_load_dwordx2 v[146:147], v12, s[28:31], s91 offen offset:32
  buffer_load_dwordx2 v[148:149], v12, s[28:31], s91 offen offset:64
  buffer_load_dwordx2 v[150:151], v12, s[28:31], s91 offen offset:96
  v_lshrrev_b32 v13, 1, v231
  v_lshlrev_b32 v13, 4, v13
  v_and_b32 v14, 1, v231
  v_lshl_add_u32 v13, v14, 2, v13
  v_add_u32 v13, v13, v232
  v_lshlrev_b32 v13, 7, v13
  v_lshl_add_u32 v13, v233, 3, v13
  v_lshrrev_b32 v15, 1, v232
  v_lshl_add_u32 v14, v14, 1, v15
  v_xor_b32 v15, 0, v14
  v_lshl_add_u32 v24, v15, 5, v13
  v_xor_b32 v15, 1, v14
  v_lshl_add_u32 v25, v15, 5, v13
  v_xor_b32 v15, 2, v14
  v_lshl_add_u32 v26, v15, 5, v13
  v_xor_b32 v15, 3, v14
  v_lshl_add_u32 v27, v15, 5, v13
  v_lshl_add_u32 v13, v231, 2, v232
  v_mul_u32_u24 v13, 224, v13
  v_lshl_add_u32 v22, v233, 3, v13
  v_add_u32 v22, 58368, v22
  v_add_u32 v23, 57344, v22
  v_mov_b32 v20, 0x3f803f80
  v_mov_b32 v21, 0x3f803f80
  v_mov_b32 v192, 0
  v_mov_b32 v193, 0
  v_mov_b32 v194, 0
  v_mov_b32 v195, 0
  v_mov_b32 v196, 0
  v_mov_b32 v197, 0
  v_mov_b32 v198, 0
  v_mov_b32 v199, 0
  v_mov_b32 v200, 0
  v_mov_b32 v201, 0
  v_mov_b32 v202, 0
  v_mov_b32 v203, 0
  v_mov_b32 v204, 0
  v_mov_b32 v205, 0
  v_mov_b32 v206, 0
  v_mov_b32 v207, 0
  v_mov_b32 v208, 0
  v_mov_b32 v209, 0
  v_mov_b32 v210, 0
  v_mov_b32 v211, 0
  v_mov_b32 v212, 0
  v_mov_b32 v213, 0
  v_mov_b32 v214, 0
  v_mov_b32 v215, 0
  v_mov_b32 v216, 0
  v_mov_b32 v217, 0
  v_mov_b32 v218, 0
  v_mov_b32 v219, 0
  s_sub_u32 s74, 3, s70
  s_mul_i32 s74, s74, 7168
  v_add_u32 v16, s74, v22
  ds_read_b64_tr_b16 v[160:161], v16 offset:0
  ds_read_b64_tr_b16 v[162:163], v16 offset:3584
  ds_read_b64_tr_b16 v[164:165], v16 offset:32
  ds_read_b64_tr_b16 v[166:167], v16 offset:3616
  ds_read_b64_tr_b16 v[168:169], v16 offset:64
  ds_read_b64_tr_b16 v[170:171], v16 offset:3648
  ds_read_b64_tr_b16 v[172:173], v16 offset:96
  ds_read_b64_tr_b16 v[174:175], v16 offset:3680
  ds_read_b64_tr_b16 v[176:177], v16 offset:128
  ds_read_b64_tr_b16 v[178:179], v16 offset:3712
  ds_read_b64_tr_b16 v[180:181], v16 offset:160
  ds_read_b64_tr_b16 v[182:183], v16 offset:3744
  ds_read_b64_tr_b16 v[184:185], v16 offset:192
  ds_read_b64_tr_b16 v[186:187], v16 offset:3776
  s_waitcnt lgkmcnt(0)
  v_mfma_f32_4x4x4_16b_bf16 v[192:195], v[160:161], v[20:21], v[192:195]
  v_mfma_f32_4x4x4_16b_bf16 v[196:199], v[164:165], v[20:21], v[196:199]
  v_mfma_f32_4x4x4_16b_bf16 v[200:203], v[168:169], v[20:21], v[200:203]
  v_mfma_f32_4x4x4_16b_bf16 v[204:207], v[172:173], v[20:21], v[204:207]
  v_mfma_f32_4x4x4_16b_bf16 v[208:211], v[176:177], v[20:21], v[208:211]
  v_mfma_f32_4x4x4_16b_bf16 v[212:215], v[180:181], v[20:21], v[212:215]
  v_mfma_f32_4x4x4_16b_bf16 v[216:219], v[184:185], v[20:21], v[216:219]
  v_mfma_f32_4x4x4_16b_bf16 v[192:195], v[162:163], v[20:21], v[192:195]
  v_mfma_f32_4x4x4_16b_bf16 v[196:199], v[166:167], v[20:21], v[196:199]
  v_mfma_f32_4x4x4_16b_bf16 v[200:203], v[170:171], v[20:21], v[200:203]
  v_mfma_f32_4x4x4_16b_bf16 v[204:207], v[174:175], v[20:21], v[204:207]
  v_mfma_f32_4x4x4_16b_bf16 v[208:211], v[178:179], v[20:21], v[208:211]
  v_mfma_f32_4x4x4_16b_bf16 v[212:215], v[182:183], v[20:21], v[212:215]
  v_mfma_f32_4x4x4_16b_bf16 v[216:219], v[186:187], v[20:21], v[216:219]
  s_cmp_eq_u32 s70, 0
  s_cbranch_scc1 Lc3_48
  s_sub_u32 s74, 7, s70
  s_mul_i32 s74, s74, 7168
  v_add_u32 v16, s74, v22
  ds_read_b64_tr_b16 v[160:161], v16 offset:0
  ds_read_b64_tr_b16 v[162:163], v16 offset:3584
  ds_read_b64_tr_b16 v[164:165], v16 offset:32
  ds_read_b64_tr_b16 v[166:167], v16 offset:3616
  ds_read_b64_tr_b16 v[168:169], v16 offset:64
  ds_read_b64_tr_b16 v[170:171], v16 offset:3648
  ds_read_b64_tr_b16 v[172:173], v16 offset:96
  ds_read_b64_tr_b16 v[174:175], v16 offset:3680
  ds_read_b64_tr_b16 v[176:177], v16 offset:128
  ds_read_b64_tr_b16 v[178:179], v16 offset:3712
  ds_read_b64_tr_b16 v[180:181], v16 offset:160
  ds_read_b64_tr_b16 v[182:183], v16 offset:3744
  ds_read_b64_tr_b16 v[184:185], v16 offset:192
  ds_read_b64_tr_b16 v[186:187], v16 offset:3776
  s_waitcnt lgkmcnt(0)
  v_mfma_f32_4x4x4_16b_bf16 v[192:195], v[160:161], v[20:21], v[192:195]
  v_mfma_f32_4x4x4_16b_bf16 v[196:199], v[164:165], v[20:21], v[196:199]
  v_mfma_f32_4x4x4_16b_bf16 v[200:203], v[168:169], v[20:21], v[200:203]
  v_mfma_f32_4x4x4_16b_bf16 v[204:207], v[172:173], v[20:21], v[204:207]
  v_mfma_f32_4x4x4_16b_bf16 v[208:211], v[176:177], v[20:21], v[208:211]
  v_mfma_f32_4x4x4_16b_bf16 v[212:215], v[180:181], v[20:21], v[212:215]
  v_mfma_f32_4x4x4_16b_bf16 v[216:219], v[184:185], v[20:21], v[216:219]
  v_mfma_f32_4x4x4_16b_bf16 v[192:195], v[162:163], v[20:21], v[192:195]
  v_mfma_f32_4x4x4_16b_bf16 v[196:199], v[166:167], v[20:21], v[196:199]
  v_mfma_f32_4x4x4_16b_bf16 v[200:203], v[170:171], v[20:21], v[200:203]
  v_mfma_f32_4x4x4_16b_bf16 v[204:207], v[174:175], v[20:21], v[204:207]
  v_mfma_f32_4x4x4_16b_bf16 v[208:211], v[178:179], v[20:21], v[208:211]
  v_mfma_f32_4x4x4_16b_bf16 v[212:215], v[182:183], v[20:21], v[212:215]
  v_mfma_f32_4x4x4_16b_bf16 v[216:219], v[186:187], v[20:21], v[216:219]
Lc3_48:
  s_waitcnt vmcnt(4)
  s_lshl_b32 s71, s68, 9
  s_lshl_b32 s72, s70, 7
  s_add_u32 s71, s71, s72
  s_lshl_b32 s72, s69, 3
  s_add_u32 s71, s71, s72
  s_add_u32 s71, s71, 16785408
  v_mov_b32 v2, s4
  v_mov_b32 v3, s5
  v_mov_b32 v4, 0
  s_mov_b64 exec, 1
  buffer_store_dwordx2 v[2:3], v4, s[60:63], s71 offen sc1
  s_mov_b64 exec, -1
  s_barrier
  s_sub_u32 s74, 10, s70
  s_mul_i32 s71, s74, 114688
  s_mul_i32 s72, s69, 224
  s_add_u32 s71, s71, s72
  s_mul_i32 s73, s74, 7168
  s_add_u32 m0, s73, 58368
  s_nop 0
  buffer_load_dwordx4 v224, s[40:43], s71 offen lds
  s_add_u32 m0, s73, 59392
  s_nop 0
  buffer_load_dwordx4 v225, s[40:43], s71 offen lds
  s_add_u32 m0, s73, 60416
  s_nop 0
  buffer_load_dwordx4 v226, s[40:43], s71 offen lds
  s_add_u32 m0, s73, 61440
  s_nop 0
  buffer_load_dwordx4 v227, s[40:43], s71 offen lds
  s_add_u32 m0, s73, 62464
  s_nop 0
  buffer_load_dwordx4 v228, s[40:43], s71 offen lds
  s_add_u32 m0, s73, 63488
  s_nop 0
  buffer_load_dwordx4 v229, s[40:43], s71 offen lds
  s_add_u32 m0, s73, 64512
  s_nop 0
  buffer_load_dwordx4 v230, s[40:43], s71 offen lds
  s_cmp_eq_u32 s70, 0
  s_cbranch_scc1 Lw1_49
  s_sub_u32 s74, 14, s70
  s_mul_i32 s71, s74, 114688
  s_mul_i32 s72, s69, 224
  s_add_u32 s71, s71, s72
  s_mul_i32 s73, s74, 7168
  s_add_u32 m0, s73, 58368
  s_nop 0
  buffer_load_dwordx4 v224, s[40:43], s71 offen lds
  s_add_u32 m0, s73, 59392
  s_nop 0
  buffer_load_dwordx4 v225, s[40:43], s71 offen lds
  s_add_u32 m0, s73, 60416
  s_nop 0
  buffer_load_dwordx4 v226, s[40:43], s71 offen lds
  s_add_u32 m0, s73, 61440
  s_nop 0
  buffer_load_dwordx4 v227, s[40:43], s71 offen lds
  s_add_u32 m0, s73, 62464
  s_nop 0
  buffer_load_dwordx4 v228, s[40:43], s71 offen lds
  s_add_u32 m0, s73, 63488
  s_nop 0
  buffer_load_dwordx4 v229, s[40:43], s71 offen lds
  s_add_u32 m0, s73, 64512
  s_nop 0
  buffer_load_dwordx4 v230, s[40:43], s71 offen lds
Lw1_49:
  s_add_u32 s74, s13, 172032
  buffer_load_dwordx4 a[104:107], v238, s[60:63], s74 offen offset:2048 sc1
  s_add_u32 s74, s13, 172032
  buffer_load_dwordx4 a[108:111], v238, s[60:63], s74 offen offset:3072 sc1
  s_add_u32 s74, s13, 200704
  buffer_load_dwordx4 a[112:115], v238, s[60:63], s74 offen offset:0 sc1
  s_add_u32 s74, s13, 200704
  buffer_load_dwordx4 a[116:119], v238, s[60:63], s74 offen offset:1024 sc1
  s_add_u32 s74, s13, 200704
  buffer_load_dwordx4 a[120:123], v238, s[60:63], s74 offen offset:2048 sc1
  s_add_u32 s74, s13, 200704
  buffer_load_dwordx4 a[124:127], v238, s[60:63], s74 offen offset:3072 sc1
  s_add_u32 s74, s13, 229376
  buffer_load_dwordx4 a[128:131], v238, s[60:63], s74 offen offset:0 sc1
  s_add_u32 s74, s13, 229376
  buffer_load_dwordx4 a[132:135], v238, s[60:63], s74 offen offset:1024 sc1
  s_add_u32 s74, s13, 229376
  buffer_load_dwordx4 a[136:139], v238, s[60:63], s74 offen offset:2048 sc1
  s_add_u32 s74, s13, 229376
  buffer_load_dwordx4 a[140:143], v238, s[60:63], s74 offen offset:3072 sc1
  s_add_u32 s74, s13, 258048
  buffer_load_dwordx4 a[144:147], v238, s[60:63], s74 offen offset:0 sc1
  s_add_u32 s74, s13, 258048
  buffer_load_dwordx4 a[148:151], v238, s[60:63], s74 offen offset:1024 sc1
  s_add_u32 s74, s13, 258048
  buffer_load_dwordx4 a[152:155], v238, s[60:63], s74 offen offset:2048 sc1
  s_add_u32 s74, s13, 258048
  buffer_load_dwordx4 a[156:159], v238, s[60:63], s74 offen offset:3072 sc1
  s_add_u32 s74, s13, 286720
  buffer_load_dwordx4 a[160:163], v238, s[60:63], s74 offen offset:0 sc1
  s_add_u32 s74, s13, 286720
  buffer_load_dwordx4 a[164:167], v238, s[60:63], s74 offen offset:1024 sc1
  s_add_u32 s74, s13, 286720
  buffer_load_dwordx4 a[168:171], v238, s[60:63], s74 offen offset:2048 sc1
  s_add_u32 s74, s13, 286720
  buffer_load_dwordx4 a[172:175], v238, s[60:63], s74 offen offset:3072 sc1
  s_add_u32 s74, s13, 315392
  buffer_load_dwordx4 a[176:179], v238, s[60:63], s74 offen offset:0 sc1
  s_add_u32 s74, s13, 315392
  buffer_load_dwordx4 a[180:183], v238, s[60:63], s74 offen offset:1024 sc1
  v_lshlrev_b32 v12, 3, v231
  s_mul_i32 s72, s69, 224
  buffer_load_dwordx2 v[240:241], v12, s[44:47], s72 offen offset:0
  buffer_load_dwordx2 v[242:243], v12, s[44:47], s72 offen offset:32
  buffer_load_dwordx2 v[244:245], v12, s[44:47], s72 offen offset:64
  buffer_load_dwordx2 v[246:247], v12, s[44:47], s72 offen offset:96
  buffer_load_dwordx2 v[248:249], v12, s[44:47], s72 offen offset:128
  buffer_load_dwordx2 v[250:251], v12, s[44:47], s72 offen offset:160
  buffer_load_dwordx2 v[252:253], v12, s[44:47], s72 offen offset:192
  s_cmp_ge_u32 s69, 14
  s_cbranch_scc1 Lp2done_50
  s_lshr_b32 s71, s76, 1
  s_lshl_b32 s71, s71, 7
  s_add_u32 s71, s71, 16785408
  v_lshl_add_u32 v4, v1, 3, s71
  s_bfm_b64 exec, 16, 0
  s_mov_b32 s72, 0
Lpoll_51:
  buffer_load_dwordx2 v[2:3], v4, s[60:63], 0 offen sc1
  s_add_u32 s72, s72, 1
  s_cmp_gt_u32 s72, 0x40000
  s_cbranch_scc1 Lend
  s_waitcnt vmcnt(0)
  v_cmp_ne_u32 vcc, s4, v2
  v_cmp_ne_u32 s[96:97], s5, v3
  s_nop 2
  s_or_b64 vcc, vcc, s[96:97]
  s_cbranch_vccnz Lpoll_51
  s_mov_b64 exec, -1
  s_lshl_b32 s77, s76, 14
  s_add_u32 s77, s77, 0
  s_add_u32 s71, s77, 0
  buffer_load_dwordx4 v[32:35], v238, s[60:63], s71 offen offset:0 sc1
  s_add_u32 s71, s77, 0
  buffer_load_dwordx4 v[36:39], v238, s[60:63], s71 offen offset:1024 sc1
  s_add_u32 s71, s77, 0
  buffer_load_dwordx4 v[40:43], v238, s[60:63], s71 offen offset:2048 sc1
  s_add_u32 s71, s77, 0
  buffer_load_dwordx4 v[44:47], v238, s[60:63], s71 offen offset:3072 sc1
  s_add_u32 s71, s77, 4096
  buffer_load_dwordx4 v[48:51], v238, s[60:63], s71 offen offset:0 sc1
  s_add_u32 s71, s77, 4096
  buffer_load_dwordx4 v[52:55], v238, s[60:63], s71 offen offset:1024 sc1
  s_add_u32 s71, s77, 4096
  buffer_load_dwordx4 v[56:59], v238, s[60:63], s71 offen offset:2048 sc1
  s_add_u32 s71, s77, 4096
  buffer_load_dwordx4 v[60:63], v238, s[60:63], s71 offen offset:3072 sc1
  ds_read_b64_tr_b16 v[112:113], v24 offset:0
  ds_read_b64_tr_b16 v[114:115], v24 offset:1024
  ds_read_b64_tr_b16 v[116:117], v25 offset:0
  ds_read_b64_tr_b16 v[118:119], v25 offset:1024
  ds_read_b64_tr_b16 v[120:121], v26 offset:0
  ds_read_b64_tr_b16 v[122:123], v26 offset:1024
  ds_read_b64_tr_b16 v[124:125], v27 offset:0
  ds_read_b64_tr_b16 v[126:127], v27 offset:1024
  s_add_u32 s71, s77, 8192
  buffer_load_dwordx4 v[64:67], v238, s[60:63], s71 offen offset:0 sc1
  ds_read_b64_tr_b16 v[128:129], v26 offset:3584
  ds_read_b64_tr_b16 v[130:131], v26 offset:4608
  ds_read_b64_tr_b16 v[132:133], v27 offset:3584
  ds_read_b64_tr_b16 v[134:135], v27 offset:4608
  ds_read_b64_tr_b16 v[136:137], v24 offset:3584
  ds_read_b64_tr_b16 v[138:139], v24 offset:4608
  ds_read_b64_tr_b16 v[140:141], v25 offset:3584
  ds_read_b64_tr_b16 v[142:143], v25 offset:4608
  s_waitcnt lgkmcnt(8)
  s_waitcnt vmcnt(8)
  v_mfma_f32_16x16x32_bf16 v[96:99], v[112:115], v[32:35], 0
  v_mfma_f32_16x16x32_bf16 v[100:103], v[116:119], v[32:35], 0
  v_mfma_f32_16x16x32_bf16 v[104:107], v[120:123], v[32:35], 0
  v_mfma_f32_16x16x32_bf16 v[108:111], v[124:127], v[32:35], 0
  s_add_u32 s71, s77, 8192
  buffer_load_dwordx4 v[68:71], v238, s[60:63], s71 offen offset:1024 sc1
  ds_read_b64_tr_b16 v[112:113], v24 offset:7168
  ds_read_b64_tr_b16 v[114:115], v24 offset:8192
  ds_read_b64_tr_b16 v[116:117], v25 offset:7168
  ds_read_b64_tr_b16 v[118:119], v25 offset:8192
  ds_read_b64_tr_b16 v[120:121], v26 offset:7168
  ds_read_b64_tr_b16 v[122:123], v26 offset:8192
  ds_read_b64_tr_b16 v[124:125], v27 offset:7168
  ds_read_b64_tr_b16 v[126:127], v27 offset:8192
  s_waitcnt lgkmcnt(8)
  s_waitcnt vmcnt(8)
  v_mfma_f32_16x16x32_bf16 v[96:99], v[128:131], v[36:39], v[96:99]
  v_mfma_f32_16x16x32_bf16 v[100:103], v[132:135], v[36:39], v[100:103]
  v_mfma_f32_16x16x32_bf16 v[104:107], v[136:139], v[36:39], v[104:107]
  v_mfma_f32_16x16x32_bf16 v[108:111], v[140:143], v[36:39], v[108:111]
  s_add_u32 s71, s77, 8192
  buffer_load_dwordx4 v[72:75], v238, s[60:63], s71 offen offset:2048 sc1
  ds_read_b64_tr_b16 v[128:129], v26 offset:10752
  ds_read_b64_tr_b16 v[130:131], v26 offset:11776
  ds_read_b64_tr_b16 v[132:133], v27 offset:10752
  ds_read_b64_tr_b16 v[134:135], v27 offset:11776
  ds_read_b64_tr_b16 v[136:137], v24 offset:10752
  ds_read_b64_tr_b16 v[138:139], v24 offset:11776
  ds_read_b64_tr_b16 v[140:141], v25 offset:10752
  ds_read_b64_tr_b16 v[142:143], v25 offset:11776
  s_waitcnt lgkmcnt(8)
  s_waitcnt vmcnt(8)
  v_mfma_f32_16x16x32_bf16 v[96:99], v[112:115], v[40:43], v[96:99]
  v_mfma_f32_16x16x32_bf16 v[100:103], v[116:119], v[40:43], v[100:103]
  v_mfma_f32_16x16x32_bf16 v[104:107], v[120:123], v[40:43], v[104:107]
  v_mfma_f32_16x16x32_bf16 v[108:111], v[124:127], v[40:43], v[108:111]
  s_add_u32 s71, s77, 8192
  buffer_load_dwordx4 v[76:79], v238, s[60:63], s71 offen offset:3072 sc1
  ds_read_b64_tr_b16 v[112:113], v24 offset:14336
  ds_read_b64_tr_b16 v[114:115], v24 offset:15360
  ds_read_b64_tr_b16 v[116:117], v25 offset:14336
  ds_read_b64_tr_b16 v[118:119], v25 offset:15360
  ds_read_b64_tr_b16 v[120:121], v26 offset:14336
  ds_read_b64_tr_b16 v[122:123], v26 offset:15360
  ds_read_b64_tr_b16 v[124:125], v27 offset:14336
  ds_read_b64_tr_b16 v[126:127], v27 offset:15360
  s_waitcnt lgkmcnt(8)
  s_waitcnt vmcnt(8)
  v_mfma_f32_16x16x32_bf16 v[96:99], v[128:131], v[44:47], v[96:99]
  v_mfma_f32_16x16x32_bf16 v[100:103], v[132:135], v[44:47], v[100:103]
  v_mfma_f32_16x16x32_bf16 v[104:107], v[136:139], v[44:47], v[104:107]
  v_mfma_f32_16x16x32_bf16 v[108:111], v[140:143], v[44:47], v[108:111]
  s_add_u32 s71, s77, 12288
  buffer_load_dwordx4 v[80:83], v238, s[60:63], s71 offen offset:0 sc1
  ds_read_b64_tr_b16 v[128:129], v26 offset:17920
  ds_read_b64_tr_b16 v[130:131], v26 offset:18944
  ds_read_b64_tr_b16 v[132:133], v27 offset:17920
  ds_read_b64_tr_b16 v[134:135], v27 offset:18944
  ds_read_b64_tr_b16 v[136:137], v24 offset:17920
  ds_read_b64_tr_b16 v[138:139], v24 offset:18944
  ds_read_b64_tr_b16 v[140:141], v25 offset:17920
  ds_read_b64_tr_b16 v[142:143], v25 offset:18944
  s_waitcnt lgkmcnt(8)
  s_waitcnt vmcnt(8)
  v_mfma_f32_16x16x32_bf16 v[96:99], v[112:115], v[48:51], v[96:99]
  v_mfma_f32_16x16x32_bf16 v[100:103], v[116:119], v[48:51], v[100:103]
  v_mfma_f32_16x16x32_bf16 v[104:107], v[120:123], v[48:51], v[104:107]
  v_mfma_f32_16x16x32_bf16 v[108:111], v[124:127], v[48:51], v[108:111]
  s_add_u32 s71, s77, 12288
  buffer_load_dwordx4 v[84:87], v238, s[60:63], s71 offen offset:1024 sc1
  ds_read_b64_tr_b16 v[112:113], v24 offset:21504
  ds_read_b64_tr_b16 v[114:115], v24 offset:22528
  ds_read_b64_tr_b16 v[116:117], v25 offset:21504
  ds_read_b64_tr_b16 v[118:119], v25 offset:22528
  ds_read_b64_tr_b16 v[120:121], v26 offset:21504
  ds_read_b64_tr_b16 v[122:123], v26 offset:22528
  ds_read_b64_tr_b16 v[124:125], v27 offset:21504
  ds_read_b64_tr_b16 v[126:127], v27 offset:22528
  s_waitcnt lgkmcnt(8)
  s_waitcnt vmcnt(8)
  v_mfma_f32_16x16x32_bf16 v[96:99], v[128:131], v[52:55], v[96:99]
  v_mfma_f32_16x16x32_bf16 v[100:103], v[132:135], v[52:55], v[100:103]
  v_mfma_f32_16x16x32_bf16 v[104:107], v[136:139], v[52:55], v[104:107]
  v_mfma_f32_16x16x32_bf16 v[108:111], v[140:143], v[52:55], v[108:111]
  s_add_u32 s71, s77, 12288
  buffer_load_dwordx4 v[88:91], v238, s[60:63], s71 offen offset:2048 sc1
  ds_read_b64_tr_b16 v[128:129], v26 offset:25088
  ds_read_b64_tr_b16 v[130:131], v26 offset:26112
  ds_read_b64_tr_b16 v[132:133], v27 offset:25088
  ds_read_b64_tr_b16 v[134:135], v27 offset:26112
  ds_read_b64_tr_b16 v[136:137], v24 offset:25088
  ds_read_b64_tr_b16 v[138:139], v24 offset:26112
  ds_read_b64_tr_b16 v[140:141], v25 offset:25088
  ds_read_b64_tr_b16 v[142:143], v25 offset:26112
  s_waitcnt lgkmcnt(8)
  s_waitcnt vmcnt(8)
  v_mfma_f32_16x16x32_bf16 v[96:99], v[112:115], v[56:59], v[96:99]
  v_mfma_f32_16x16x32_bf16 v[100:103], v[116:119], v[56:59], v[100:103]
  v_mfma_f32_16x16x32_bf16 v[104:107], v[120:123], v[56:59], v[104:107]
  v_mfma_f32_16x16x32_bf16 v[108:111], v[124:127], v[56:59], v[108:111]
  s_add_u32 s71, s77, 12288
  buffer_load_dwordx4 v[92:95], v238, s[60:63], s71 offen offset:3072 sc1
  ds_read_b64_tr_b16 v[112:113], v24 offset:28672
  ds_read_b64_tr_b16 v[114:115], v24 offset:29696
  ds_read_b64_tr_b16 v[116:117], v25 offset:28672
  ds_read_b64_tr_b16 v[118:119], v25 offset:29696
  ds_read_b64_tr_b16 v[120:121], v26 offset:28672
  ds_read_b64_tr_b16 v[122:123], v26 offset:29696
  ds_read_b64_tr_b16 v[124:125], v27 offset:28672
  ds_read_b64_tr_b16 v[126:127], v27 offset:29696
  s_waitcnt lgkmcnt(8)
  s_waitcnt vmcnt(8)
  v_mfma_f32_16x16x32_bf16 v[96:99], v[128:131], v[60:63], v[96:99]
  v_mfma_f32_16x16x32_bf16 v[100:103], v[132:135], v[60:63], v[100:103]
  v_mfma_f32_16x16x32_bf16 v[104:107], v[136:139], v[60:63], v[104:107]
  v_mfma_f32_16x16x32_bf16 v[108:111], v[140:143], v[60:63], v[108:111]
  ds_read_b64_tr_b16 v[128:129], v26 offset:32256
  ds_read_b64_tr_b16 v[130:131], v26 offset:33280
  ds_read_b64_tr_b16 v[132:133], v27 offset:32256
  ds_read_b64_tr_b16 v[134:135], v27 offset:33280
  ds_read_b64_tr_b16 v[136:137], v24 offset:32256
  ds_read_b64_tr_b16 v[138:139], v24 offset:33280
  ds_read_b64_tr_b16 v[140:141], v25 offset:32256
  ds_read_b64_tr_b16 v[142:143], v25 offset:33280
  s_waitcnt lgkmcnt(8)
  s_waitcnt vmcnt(7)
  v_mfma_f32_16x16x32_bf16 v[96:99], v[112:115], v[64:67], v[96:99]
  v_mfma_f32_16x16x32_bf16 v[100:103], v[116:119], v[64:67], v[100:103]
  v_mfma_f32_16x16x32_bf16 v[104:107], v[120:123], v[64:67], v[104:107]
  v_mfma_f32_16x16x32_bf16 v[108:111], v[124:127], v[64:67], v[108:111]
  ds_read_b64_tr_b16 v[112:113], v24 offset:35840
  ds_read_b64_tr_b16 v[114:115], v24 offset:36864
  ds_read_b64_tr_b16 v[116:117], v25 offset:35840
  ds_read_b64_tr_b16 v[118:119], v25 offset:36864
  ds_read_b64_tr_b16 v[120:121], v26 offset:35840
  ds_read_b64_tr_b16 v[122:123], v26 offset:36864
  ds_read_b64_tr_b16 v[124:125], v27 offset:35840
  ds_read_b64_tr_b16 v[126:127], v27 offset:36864
  s_waitcnt lgkmcnt(8)
  s_waitcnt vmcnt(6)
  v_mfma_f32_16x16x32_bf16 v[96:99], v[128:131], v[68:71], v[96:99]
  v_mfma_f32_16x16x32_bf16 v[100:103], v[132:135], v[68:71], v[100:103]
  v_mfma_f32_16x16x32_bf16 v[104:107], v[136:139], v[68:71], v[104:107]
  v_mfma_f32_16x16x32_bf16 v[108:111], v[140:143], v[68:71], v[108:111]
  ds_read_b64_tr_b16 v[128:129], v26 offset:39424
  ds_read_b64_tr_b16 v[130:131], v26 offset:40448
  ds_read_b64_tr_b16 v[132:133], v27 offset:39424
  ds_read_b64_tr_b16 v[134:135], v27 offset:40448
  ds_read_b64_tr_b16 v[136:137], v24 offset:39424
  ds_read_b64_tr_b16 v[138:139], v24 offset:40448
  ds_read_b64_tr_b16 v[140:141], v25 offset:39424
  ds_read_b64_tr_b16 v[142:143], v25 offset:40448
  s_waitcnt lgkmcnt(8)
  s_waitcnt vmcnt(5)
  v_mfma_f32_16x16x32_bf16 v[96:99], v[112:115], v[72:75], v[96:99]
  v_mfma_f32_16x16x32_bf16 v[100:103], v[116:119], v[72:75], v[100:103]
  v_mfma_f32_16x16x32_bf16 v[104:107], v[120:123], v[72:75], v[104:107]
  v_mfma_f32_16x16x32_bf16 v[108:111], v[124:127], v[72:75], v[108:111]
  ds_read_b64_tr_b16 v[112:113], v24 offset:43008
  ds_read_b64_tr_b16 v[114:115], v24 offset:44032
  ds_read_b64_tr_b16 v[116:117], v25 offset:43008
  ds_read_b64_tr_b16 v[118:119], v25 offset:44032
  ds_read_b64_tr_b16 v[120:121], v26 offset:43008
  ds_read_b64_tr_b16 v[122:123], v26 offset:44032
  ds_read_b64_tr_b16 v[124:125], v27 offset:43008
  ds_read_b64_tr_b16 v[126:127], v27 offset:44032
  s_waitcnt lgkmcnt(8)
  s_waitcnt vmcnt(4)
  v_mfma_f32_16x16x32_bf16 v[96:99], v[128:131], v[76:79], v[96:99]
  v_mfma_f32_16x16x32_bf16 v[100:103], v[132:135], v[76:79], v[100:103]
  v_mfma_f32_16x16x32_bf16 v[104:107], v[136:139], v[76:79], v[104:107]
  v_mfma_f32_16x16x32_bf16 v[108:111], v[140:143], v[76:79], v[108:111]
  ds_read_b64_tr_b16 v[128:129], v26 offset:46592
  ds_read_b64_tr_b16 v[130:131], v26 offset:47616
  ds_read_b64_tr_b16 v[132:133], v27 offset:46592
  ds_read_b64_tr_b16 v[134:135], v27 offset:47616
  ds_read_b64_tr_b16 v[136:137], v24 offset:46592
  ds_read_b64_tr_b16 v[138:139], v24 offset:47616
  ds_read_b64_tr_b16 v[140:141], v25 offset:46592
  ds_read_b64_tr_b16 v[142:143], v25 offset:47616
  s_waitcnt lgkmcnt(8)
  s_waitcnt vmcnt(3)
  v_mfma_f32_16x16x32_bf16 v[96:99], v[112:115], v[80:83], v[96:99]
  v_mfma_f32_16x16x32_bf16 v[100:103], v[116:119], v[80:83], v[100:103]
  v_mfma_f32_16x16x32_bf16 v[104:107], v[120:123], v[80:83], v[104:107]
  v_mfma_f32_16x16x32_bf16 v[108:111], v[124:127], v[80:83], v[108:111]
  ds_read_b64_tr_b16 v[112:113], v24 offset:50176
  ds_read_b64_tr_b16 v[114:115], v24 offset:51200
  ds_read_b64_tr_b16 v[116:117], v25 offset:50176
  ds_read_b64_tr_b16 v[118:119], v25 offset:51200
  ds_read_b64_tr_b16 v[120:121], v26 offset:50176
  ds_read_b64_tr_b16 v[122:123], v26 offset:51200
  ds_read_b64_tr_b16 v[124:125], v27 offset:50176
  ds_read_b64_tr_b16 v[126:127], v27 offset:51200
  s_waitcnt lgkmcnt(8)
  s_waitcnt vmcnt(2)
  v_mfma_f32_16x16x32_bf16 v[96:99], v[128:131], v[84:87], v[96:99]
  v_mfma_f32_16x16x32_bf16 v[100:103], v[132:135], v[84:87], v[100:103]
  v_mfma_f32_16x16x32_bf16 v[104:107], v[136:139], v[84:87], v[104:107]
  v_mfma_f32_16x16x32_bf16 v[108:111], v[140:143], v[84:87], v[108:111]
  ds_read_b64_tr_b16 v[128:129], v26 offset:53760
  ds_read_b64_tr_b16 v[130:131], v26 offset:54784
  ds_read_b64_tr_b16 v[132:133], v27 offset:53760
  ds_read_b64_tr_b16 v[134:135], v27 offset:54784
  ds_read_b64_tr_b16 v[136:137], v24 offset:53760
  ds_read_b64_tr_b16 v[138:139], v24 offset:54784
  ds_read_b64_tr_b16 v[140:141], v25 offset:53760
  ds_read_b64_tr_b16 v[142:143], v25 offset:54784
  s_waitcnt lgkmcnt(8)
  s_waitcnt vmcnt(1)
  v_mfma_f32_16x16x32_bf16 v[96:99], v[112:115], v[88:91], v[96:99]
  v_mfma_f32_16x16x32_bf16 v[100:103], v[116:119], v[88:91], v[100:103]
  v_mfma_f32_16x16x32_bf16 v[104:107], v[120:123], v[88:91], v[104:107]
  v_mfma_f32_16x16x32_bf16 v[108:111], v[124:127], v[88:91], v[108:111]
  s_waitcnt lgkmcnt(0)
  s_waitcnt vmcnt(0)
  v_mfma_f32_16x16x32_bf16 v[96:99], v[128:131], v[92:95], v[96:99]
  v_mfma_f32_16x16x32_bf16 v[100:103], v[132:135], v[92:95], v[100:103]
  v_mfma_f32_16x16x32_bf16 v[104:107], v[136:139], v[92:95], v[104:107]
  v_mfma_f32_16x16x32_bf16 v[108:111], v[140:143], v[92:95], v[108:111]
  v_lshlrev_b32 v152, 16, v144
  v_and_b32 v153, 0xffff0000, v144
  s_nop 2
  v_add_f32 v96, v96, v152
  v_add_f32 v97, v97, v153
  v_lshlrev_b32 v152, 16, v145
  v_and_b32 v153, 0xffff0000, v145
  v_add_f32 v98, v98, v152
  v_add_f32 v99, v99, v153
  v_lshlrev_b32 v152, 16, v146
  v_and_b32 v153, 0xffff0000, v146
  v_add_f32 v100, v100, v152
  v_add_f32 v101, v101, v153
  v_lshlrev_b32 v152, 16, v147
  v_and_b32 v153, 0xffff0000, v147
  v_add_f32 v102, v102, v152
  v_add_f32 v103, v103, v153
  v_lshlrev_b32 v152, 16, v148
  v_and_b32 v153, 0xffff0000, v148
  v_add_f32 v104, v104, v152
  v_add_f32 v105, v105, v153
  v_lshlrev_b32 v152, 16, v149
  v_and_b32 v153, 0xffff0000, v149
  v_add_f32 v106, v106, v152
  v_add_f32 v107, v107, v153
  v_lshlrev_b32 v152, 16, v150
  v_and_b32 v153, 0xffff0000, v150
  v_add_f32 v108, v108, v152
  v_add_f32 v109, v109, v153
  v_lshlrev_b32 v152, 16, v151
  v_and_b32 v153, 0xffff0000, v151
  v_add_f32 v110, v110, v152
  v_add_f32 v111, v111, v153
  v_cvt_pk_bf16_f32 v156, v96, v97
  v_cvt_pk_bf16_f32 v157, v98, v99
  v_cvt_pk_bf16_f32 v158, v100, v101
  v_cvt_pk_bf16_f32 v159, v102, v103
  v_cvt_pk_bf16_f32 v160, v104, v105
  v_cvt_pk_bf16_f32 v161, v106, v107
  v_cvt_pk_bf16_f32 v162, v108, v109
  v_cvt_pk_bf16_f32 v163, v110, v111
  s_mul_i32 s71, s76, 14
  s_lshl_b32 s72, s92, 1
  s_add_u32 s71, s71, s72
  s_lshl_b32 s71, s71, 10
  s_add_u32 s71, s71, 2097152
  buffer_store_dwordx4 v[156:159], v238, s[60:63], s71 offen sc1
  buffer_store_dwordx4 v[160:163], v238, s[60:63], s71 offen offset:1024 sc1
  v_mov_b32 v16, v96
  v_mul_f32 v17, v96, v96
  v_add_f32 v16, v16, v97
  v_fmac_f32 v17, v97, v97
  v_add_f32 v16, v16, v98
  v_fmac_f32 v17, v98, v98
  v_add_f32 v16, v16, v99
  v_fmac_f32 v17, v99, v99
  v_add_f32 v16, v16, v100
  v_fmac_f32 v17, v100, v100
  v_add_f32 v16, v16, v101
  v_fmac_f32 v17, v101, v101
  v_add_f32 v16, v16, v102
  v_fmac_f32 v17, v102, v102
  v_add_f32 v16, v16, v103
  v_fmac_f32 v17, v103, v103
  v_add_f32 v16, v16, v104
  v_fmac_f32 v17, v104, v104
  v_add_f32 v16, v16, v105
  v_fmac_f32 v17, v105, v105
  v_add_f32 v16, v16, v106
  v_fmac_f32 v17, v106, v106
  v_add_f32 v16, v16, v107
  v_fmac_f32 v17, v107, v107
  v_add_f32 v16, v16, v108
  v_fmac_f32 v17, v108, v108
  v_add_f32 v16, v16, v109
  v_fmac_f32 v17, v109, v109
  v_add_f32 v16, v16, v110
  v_fmac_f32 v17, v110, v110
  v_add_f32 v16, v16, v111
  v_fmac_f32 v17, v111, v111
  v_mov_b32 v152, v16
  s_nop 1
  v_permlane32_swap_b32 v16, v152
  v_add_f32 v16, v16, v152
  v_mov_b32 v152, v16
  s_nop 1
  v_permlane16_swap_b32 v16, v152
  v_add_f32 v16, v16, v152
  v_mov_b32 v152, v17
  s_nop 1
  v_permlane32_swap_b32 v17, v152
  v_add_f32 v17, v17, v152
  v_mov_b32 v152, v17
  s_nop 1
  v_permlane16_swap_b32 v17, v152
  v_add_f32 v17, v17, v152
  v_mov_b32 v152, v16
  v_mov_b32 v153, v17
  s_lshl_b32 s71, s92, 3
  s_add_u32 s71, s71, 4194304
  v_lshlrev_b32 v11, 6, v11
  s_mov_b64 exec, 0xffff
  buffer_store_dwordx2 v[152:153], v11, s[60:63], s71 offen sc1
  s_mov_b64 exec, -1
  s_waitcnt vmcnt(0)
  s_lshl_b32 s71, s76, 6
  s_lshl_b32 s72, s92, 3
  s_add_u32 s71, s71, s72
  s_add_u32 s71, s71, 16793600
  v_mov_b32 v2, s4
  v_mov_b32 v3, s5
  v_mov_b32 v4, 0
  s_mov_b64 exec, 1
  buffer_store_dwordx2 v[2:3], v4, s[60:63], s71 offen sc1
  s_mov_b64 exec, -1
  s_branch Lp2j_53
Lp2done_50:
  s_waitcnt vmcnt(0)
Lp2j_53:
  s_barrier
  s_lshl_b32 s77, s68, 3
  s_lshl_b32 s71, s70, 1
  s_add_u32 s77, s77, s71
  s_add_u32 s74, s13, 315392
  buffer_load_dwordx4 a[184:187], v238, s[60:63], s74 offen offset:2048 sc1
  s_add_u32 s74, s13, 315392
  buffer_load_dwordx4 a[188:191], v238, s[60:63], s74 offen offset:3072 sc1
  s_add_u32 s74, s13, 344064
  buffer_load_dwordx4 a[192:195], v238, s[60:63], s74 offen offset:0 sc1
  s_add_u32 s74, s13, 344064
  buffer_load_dwordx4 a[196:199], v238, s[60:63], s74 offen offset:1024 sc1
  s_add_u32 s74, s13, 344064
  buffer_load_dwordx4 a[200:203], v238, s[60:63], s74 offen offset:2048 sc1
  s_add_u32 s74, s13, 344064
  buffer_load_dwordx4 a[204:207], v238, s[60:63], s74 offen offset:3072 sc1
  s_add_u32 s74, s13, 372736
  buffer_load_dwordx4 a[208:211], v238, s[60:63], s74 offen offset:0 sc1
  s_add_u32 s74, s13, 372736
  buffer_load_dwordx4 a[212:215], v238, s[60:63], s74 offen offset:1024 sc1
  s_add_u32 s74, s13, 372736
  buffer_load_dwordx4 a[216:219], v238, s[60:63], s74 offen offset:2048 sc1
  s_add_u32 s74, s13, 372736
  buffer_load_dwordx4 a[220:223], v238, s[60:63], s74 offen offset:3072 sc1
  s_sub_u32 s74, 10, s70
  s_mul_i32 s74, s74, 7168
  v_add_u32 v16, s74, v22
  ds_read_b64_tr_b16 v[160:161], v16 offset:0
  ds_read_b64_tr_b16 v[162:163], v16 offset:3584
  ds_read_b64_tr_b16 v[164:165], v16 offset:32
  ds_read_b64_tr_b16 v[166:167], v16 offset:3616
  ds_read_b64_tr_b16 v[168:169], v16 offset:64
  ds_read_b64_tr_b16 v[170:171], v16 offset:3648
  ds_read_b64_tr_b16 v[172:173], v16 offset:96
  ds_read_b64_tr_b16 v[174:175], v16 offset:3680
  ds_read_b64_tr_b16 v[176:177], v16 offset:128
  ds_read_b64_tr_b16 v[178:179], v16 offset:3712
  ds_read_b64_tr_b16 v[180:181], v16 offset:160
  ds_read_b64_tr_b16 v[182:183], v16 offset:3744
  ds_read_b64_tr_b16 v[184:185], v16 offset:192
  ds_read_b64_tr_b16 v[186:187], v16 offset:3776
  s_waitcnt lgkmcnt(0)
  v_mfma_f32_4x4x4_16b_bf16 v[192:195], v[160:161], v[20:21], v[192:195]
  v_mfma_f32_4x4x4_16b_bf16 v[196:199], v[164:165], v[20:21], v[196:199]
  v_mfma_f32_4x4x4_16b_bf16 v[200:203], v[168:169], v[20:21], v[200:203]
  v_mfma_f32_4x4x4_16b_bf16 v[204:207], v[172:173], v[20:21], v[204:207]
  v_mfma_f32_4x4x4_16b_bf16 v[208:211], v[176:177], v[20:21], v[208:211]
  v_mfma_f32_4x4x4_16b_bf16 v[212:215], v[180:181], v[20:21], v[212:215]
  v_mfma_f32_4x4x4_16b_bf16 v[216:219], v[184:185], v[20:21], v[216:219]
  v_mfma_f32_4x4x4_16b_bf16 v[192:195], v[162:163], v[20:21], v[192:195]
  v_mfma_f32_4x4x4_16b_bf16 v[196:199], v[166:167], v[20:21], v[196:199]
  v_mfma_f32_4x4x4_16b_bf16 v[200:203], v[170:171], v[20:21], v[200:203]
  v_mfma_f32_4x4x4_16b_bf16 v[204:207], v[174:175], v[20:21], v[204:207]
  v_mfma_f32_4x4x4_16b_bf16 v[208:211], v[178:179], v[20:21], v[208:211]
  v_mfma_f32_4x4x4_16b_bf16 v[212:215], v[182:183], v[20:21], v[212:215]
  v_mfma_f32_4x4x4_16b_bf16 v[216:219], v[186:187], v[20:21], v[216:219]
  s_cmp_eq_u32 s70, 0
  s_cbranch_scc1 Lc3_54
  s_sub_u32 s74, 14, s70
  s_mul_i32 s74, s74, 7168
  v_add_u32 v16, s74, v22
  ds_read_b64_tr_b16 v[160:161], v16 offset:0
  ds_read_b64_tr_b16 v[162:163], v16 offset:3584
  ds_read_b64_tr_b16 v[164:165], v16 offset:32
  ds_read_b64_tr_b16 v[166:167], v16 offset:3616
  ds_read_b64_tr_b16 v[168:169], v16 offset:64
  ds_read_b64_tr_b16 v[170:171], v16 offset:3648
  ds_read_b64_tr_b16 v[172:173], v16 offset:96
  ds_read_b64_tr_b16 v[174:175], v16 offset:3680
  ds_read_b64_tr_b16 v[176:177], v16 offset:128
  ds_read_b64_tr_b16 v[178:179], v16 offset:3712
  ds_read_b64_tr_b16 v[180:181], v16 offset:160
  ds_read_b64_tr_b16 v[182:183], v16 offset:3744
  ds_read_b64_tr_b16 v[184:185], v16 offset:192
  ds_read_b64_tr_b16 v[186:187], v16 offset:3776
  s_waitcnt lgkmcnt(0)
  v_mfma_f32_4x4x4_16b_bf16 v[192:195], v[160:161], v[20:21], v[192:195]
  v_mfma_f32_4x4x4_16b_bf16 v[196:199], v[164:165], v[20:21], v[196:199]
  v_mfma_f32_4x4x4_16b_bf16 v[200:203], v[168:169], v[20:21], v[200:203]
  v_mfma_f32_4x4x4_16b_bf16 v[204:207], v[172:173], v[20:21], v[204:207]
  v_mfma_f32_4x4x4_16b_bf16 v[208:211], v[176:177], v[20:21], v[208:211]
  v_mfma_f32_4x4x4_16b_bf16 v[212:215], v[180:181], v[20:21], v[212:215]
  v_mfma_f32_4x4x4_16b_bf16 v[216:219], v[184:185], v[20:21], v[216:219]
  v_mfma_f32_4x4x4_16b_bf16 v[192:195], v[162:163], v[20:21], v[192:195]
  v_mfma_f32_4x4x4_16b_bf16 v[196:199], v[166:167], v[20:21], v[196:199]
  v_mfma_f32_4x4x4_16b_bf16 v[200:203], v[170:171], v[20:21], v[200:203]
  v_mfma_f32_4x4x4_16b_bf16 v[204:207], v[174:175], v[20:21], v[204:207]
  v_mfma_f32_4x4x4_16b_bf16 v[208:211], v[178:179], v[20:21], v[208:211]
  v_mfma_f32_4x4x4_16b_bf16 v[212:215], v[182:183], v[20:21], v[212:215]
  v_mfma_f32_4x4x4_16b_bf16 v[216:219], v[186:187], v[20:21], v[216:219]
Lc3_54:
  v_cmp_eq_u32 s[80:81], 1, v233
  v_cmp_eq_u32 s[82:83], 2, v233
  v_cmp_eq_u32 s[84:85], 3, v233
  v_cmp_lt_u32 s[86:87], 15, v1
  v_and_b32 v5, 15, v1
  v_lshlrev_b32 v5, 4, v5
  v_add_u32 v5, 158720, v5
  s_lshl_b32 s71, s70, 2
  v_add_u32 v6, s71, v5
  v_cndmask_b32 v192, v192, v193, s[80:81]
  v_cndmask_b32 v192, v192, v194, s[82:83]
  v_cndmask_b32 v192, v192, v195, s[84:85]
  v_mov_b32 v193, v192
  s_nop 1
  v_permlane32_swap_b32 v192, v193
  v_add_f32 v192, v192, v193
  v_mov_b32 v193, v192
  s_nop 1
  v_permlane16_swap_b32 v192, v193
  v_add_f32 v192, v192, v193
  ds_write_b32 v6, v192 offset:0
  v_cndmask_b32 v196, v196, v197, s[80:81]
  v_cndmask_b32 v196, v196, v198, s[82:83]
  v_cndmask_b32 v196, v196, v199, s[84:85]
  v_mov_b32 v197, v196
  s_nop 1
  v_permlane32_swap_b32 v196, v197
  v_add_f32 v196, v196, v197
  v_mov_b32 v197, v196
  s_nop 1
  v_permlane16_swap_b32 v196, v197
  v_add_f32 v196, v196, v197
  ds_write_b32 v6, v196 offset:256
  v_cndmask_b32 v200, v200, v201, s[80:81]
  v_cndmask_b32 v200, v200, v202, s[82:83]
  v_cndmask_b32 v200, v200, v203, s[84:85]
  v_mov_b32 v201, v200
  s_nop 1
  v_permlane32_swap_b32 v200, v201
  v_add_f32 v200, v200, v201
  v_mov_b32 v201, v200
  s_nop 1
  v_permlane16_swap_b32 v200, v201
  v_add_f32 v200, v200, v201
  ds_write_b32 v6, v200 offset:512
  v_cndmask_b32 v204, v204, v205, s[80:81]
  v_cndmask_b32 v204, v204, v206, s[82:83]
  v_cndmask_b32 v204, v204, v207, s[84:85]
  v_mov_b32 v205, v204
  s_nop 1
  v_permlane32_swap_b32 v204, v205
  v_add_f32 v204, v204, v205
  v_mov_b32 v205, v204
  s_nop 1
  v_permlane16_swap_b32 v204, v205
  v_add_f32 v204, v204, v205
  ds_write_b32 v6, v204 offset:768
  v_cndmask_b32 v208, v208, v209, s[80:81]
  v_cndmask_b32 v208, v208, v210, s[82:83]
  v_cndmask_b32 v208, v208, v211, s[84:85]
  v_mov_b32 v209, v208
  s_nop 1
  v_permlane32_swap_b32 v208, v209
  v_add_f32 v208, v208, v209
  v_mov_b32 v209, v208
  s_nop 1
  v_permlane16_swap_b32 v208, v209
  v_add_f32 v208, v208, v209
  ds_write_b32 v6, v208 offset:1024
  v_cndmask_b32 v212, v212, v213, s[80:81]
  v_cndmask_b32 v212, v212, v214, s[82:83]
  v_cndmask_b32 v212, v212, v215, s[84:85]
  v_mov_b32 v213, v212
  s_nop 1
  v_permlane32_swap_b32 v212, v213
  v_add_f32 v212, v212, v213
  v_mov_b32 v213, v212
  s_nop 1
  v_permlane16_swap_b32 v212, v213
  v_add_f32 v212, v212, v213
  ds_write_b32 v6, v212 offset:1280
  v_cndmask_b32 v216, v216, v217, s[80:81]
  v_cndmask_b32 v216, v216, v218, s[82:83]
  v_cndmask_b32 v216, v216, v219, s[84:85]
  v_mov_b32 v217, v216
  s_nop 1
  v_permlane32_swap_b32 v216, v217
  v_add_f32 v216, v216, v217
  v_mov_b32 v217, v216
  s_nop 1
  v_permlane16_swap_b32 v216, v217
  v_add_f32 v216, v216, v217
  ds_write_b32 v6, v216 offset:1536
  v_lshlrev_b32 v18, 16, v240
  v_accvgpr_write_b32 a224, v18
  v_and_b32 v18, 0xffff0000, v240
  v_accvgpr_write_b32 a225, v18
  v_lshlrev_b32 v18, 16, v241
  v_accvgpr_write_b32 a226, v18
  v_and_b32 v18, 0xffff0000, v241
  v_accvgpr_write_b32 a227, v18
  v_lshlrev_b32 v18, 16, v242
  v_accvgpr_write_b32 a228, v18
  v_and_b32 v18, 0xffff0000, v242
  v_accvgpr_write_b32 a229, v18
  v_lshlrev_b32 v18, 16, v243
  v_accvgpr_write_b32 a230, v18
  v_and_b32 v18, 0xffff0000, v243
  v_accvgpr_write_b32 a231, v18
  v_lshlrev_b32 v18, 16, v244
  v_accvgpr_write_b32 a232, v18
  v_and_b32 v18, 0xffff0000, v244
  v_accvgpr_write_b32 a233, v18
  v_lshlrev_b32 v18, 16, v245
  v_accvgpr_write_b32 a234, v18
  v_and_b32 v18, 0xffff0000, v245
  v_accvgpr_write_b32 a235, v18
  v_lshlrev_b32 v18, 16, v246
  v_accvgpr_write_b32 a236, v18
  v_and_b32 v18, 0xffff0000, v246
  v_accvgpr_write_b32 a237, v18
  v_lshlrev_b32 v18, 16, v247
  v_accvgpr_write_b32 a238, v18
  v_and_b32 v18, 0xffff0000, v247
  v_accvgpr_write_b32 a239, v18
  v_lshlrev_b32 v18, 16, v248
  v_accvgpr_write_b32 a240, v18
  v_and_b32 v18, 0xffff0000, v248
  v_accvgpr_write_b32 a241, v18
  v_lshlrev_b32 v18, 16, v249
  v_accvgpr_write_b32 a242, v18
  v_and_b32 v18, 0xffff0000, v249
  v_accvgpr_write_b32 a243, v18
  v_lshlrev_b32 v18, 16, v250
  v_accvgpr_write_b32 a244, v18
  v_and_b32 v18, 0xffff0000, v250
  v_accvgpr_write_b32 a245, v18
  v_lshlrev_b32 v18, 16, v251
  v_accvgpr_write_b32 a246, v18
  v_and_b32 v18, 0xffff0000, v251
  v_accvgpr_write_b32 a247, v18
  v_lshlrev_b32 v18, 16, v252
  v_accvgpr_write_b32 a248, v18
  v_and_b32 v18, 0xffff0000, v252
  v_accvgpr_write_b32 a249, v18
  v_lshlrev_b32 v18, 16, v253
  v_accvgpr_write_b32 a250, v18
  v_and_b32 v18, 0xffff0000, v253
  v_accvgpr_write_b32 a251, v18
  s_waitcnt lgkmcnt(0)
  s_barrier
  ds_read_b128 v[144:147], v5 offset:0
  ds_read_b128 v[148:151], v5 offset:256
  ds_read_b128 v[152:155], v5 offset:512
  ds_read_b128 v[156:159], v5 offset:768
  ds_read_b128 v[160:163], v5 offset:1024
  ds_read_b128 v[164:167], v5 offset:1280
  ds_read_b128 v[168:171], v5 offset:1536
  s_waitcnt lgkmcnt(0)
  v_add_f32 v144, v144, v145
  v_add_f32 v146, v146, v147
  v_add_f32 v144, v144, v146
  v_cvt_pk_bf16_f32 v240, v144, v144
  v_lshlrev_b32 v146, 16, v240
  v_sub_f32 v146, v144, v146
  v_cvt_pk_bf16_f32 v241, v146, v146
  v_add_f32 v148, v148, v149
  v_add_f32 v150, v150, v151
  v_add_f32 v148, v148, v150
  v_cvt_pk_bf16_f32 v242, v148, v148
  v_lshlrev_b32 v150, 16, v242
  v_sub_f32 v150, v148, v150
  v_cvt_pk_bf16_f32 v243, v150, v150
  v_add_f32 v152, v152, v153
  v_add_f32 v154, v154, v155
  v_add_f32 v152, v152, v154
  v_cvt_pk_bf16_f32 v244, v152, v152
  v_lshlrev_b32 v154, 16, v244
  v_sub_f32 v154, v152, v154
  v_cvt_pk_bf16_f32 v245, v154, v154
  v_add_f32 v156, v156, v157
  v_add_f32 v158, v158, v159
  v_add_f32 v156, v156, v158
  v_cvt_pk_bf16_f32 v246, v156, v156
  v_lshlrev_b32 v158, 16, v246
  v_sub_f32 v158, v156, v158
  v_cvt_pk_bf16_f32 v247, v158, v158
  v_add_f32 v160, v160, v161
  v_add_f32 v162, v162, v163
  v_add_f32 v160, v160, v162
  v_cvt_pk_bf16_f32 v248, v160, v160
  v_lshlrev_b32 v162, 16, v248
  v_sub_f32 v162, v160, v162
  v_cvt_pk_bf16_f32 v249, v162, v162
  v_add_f32 v164, v164, v165
  v_add_f32 v166, v166, v167
  v_add_f32 v164, v164, v166
  v_cvt_pk_bf16_f32 v250, v164, v164
  v_lshlrev_b32 v166, 16, v250
  v_sub_f32 v166, v164, v166
  v_cvt_pk_bf16_f32 v251, v166, v166
  v_add_f32 v168, v168, v169
  v_add_f32 v170, v170, v171
  v_add_f32 v168, v168, v170
  v_cvt_pk_bf16_f32 v252, v168, v168
  v_lshlrev_b32 v170, 16, v252
  v_sub_f32 v170, v168, v170
  v_cvt_pk_bf16_f32 v253, v170, v170
  v_and_b32 v11, 15, v1
  s_lshl_b32 s72, s77, 4
  v_add_u32 v11, s72, v11
  v_lshlrev_b32 v11, 6, v11
  v_lshl_add_u32 v11, v231, 4, v11
  v_cmp_eq_u32 s[82:83], 3, v231
  s_mul_i32 s80, s77, 14336
  s_add_u32 s80, s80, 2097152
  s_lshl_b32 s71, s77, 6
  s_add_u32 s71, s71, 16793600
  v_and_b32 v4, 7, v1
  v_min_u32 v4, 6, v4
  v_and_b32 v3, 8, v1
  v_add_u32 v4, v4, v3
  v_lshl_add_u32 v4, v4, 3, s71
  s_bfm_b64 exec, 16, 0
  s_mov_b32 s72, 0
Lpoll_55:
  buffer_load_dwordx2 v[2:3], v4, s[60:63], 0 offen sc1
  s_add_u32 s72, s72, 1
  s_cmp_gt_u32 s72, 0x40000
  s_cbranch_scc1 Lend
  s_waitcnt vmcnt(0)
  v_cmp_ne_u32 vcc, s4, v2
  v_cmp_ne_u32 s[96:97], s5, v3
  s_nop 2
  s_or_b64 vcc, vcc, s[96:97]
  s_cbranch_vccnz Lpoll_55
  s_mov_b64 exec, -1
  s_add_u32 s72, s80, 0
  buffer_load_dwordx4 v[32:35], v238, s[60:63], s72 offen offset:0 sc1
  s_add_u32 s72, s80, 12288
  buffer_load_dwordx4 v[36:39], v238, s[60:63], s72 offen offset:2048 sc1
  s_mov_b32 s72, 4194304
  buffer_load_dwordx4 v[220:223], v11, s[60:63], s72 offen offset:0 sc1
  buffer_load_dwordx4 v[224:227], v11, s[60:63], s72 offen offset:1024 sc1
  s_add_u32 s72, s80, 0
  buffer_load_dwordx4 v[40:43], v238, s[60:63], s72 offen offset:1024 sc1
  s_add_u32 s72, s80, 12288
  buffer_load_dwordx4 v[44:47], v238, s[60:63], s72 offen offset:3072 sc1
  s_add_u32 s72, s80, 0
  buffer_load_dwordx4 v[48:51], v238, s[60:63], s72 offen offset:2048 sc1
  s_add_u32 s72, s80, 16384
  buffer_load_dwordx4 v[52:55], v238, s[60:63], s72 offen offset:0 sc1
  s_add_u32 s72, s80, 0
  buffer_load_dwordx4 v[56:59], v238, s[60:63], s72 offen offset:3072 sc1
  s_add_u32 s72, s80, 16384
  buffer_load_dwordx4 v[60:63], v238, s[60:63], s72 offen offset:1024 sc1
  s_add_u32 s72, s80, 4096
  buffer_load_dwordx4 v[64:67], v238, s[60:63], s72 offen offset:0 sc1
  s_add_u32 s72, s80, 16384
  buffer_load_dwordx4 v[68:71], v238, s[60:63], s72 offen offset:2048 sc1
  s_lshr_b32 s71, s69, 1
  s_mul_i32 s71, s71, 7
  s_mul_i32 s81, s77, 56
  s_add_u32 s81, s81, s71
  s_lshl_b32 s81, s81, 10
  s_add_u32 s81, s81, 4718592
  s_and_b32 s88, s69, 1
  ds_read_b64_tr_b16 v[200:201], v22 offset:0
  ds_read_b64_tr_b16 v[202:203], v22 offset:3584
  ds_read_b64_tr_b16 v[204:205], v22 offset:32
  ds_read_b64_tr_b16 v[206:207], v22 offset:3616
  ds_read_b64_tr_b16 v[208:209], v22 offset:64
  ds_read_b64_tr_b16 v[210:211], v22 offset:3648
  ds_read_b64_tr_b16 v[212:213], v22 offset:96
  ds_read_b64_tr_b16 v[214:215], v22 offset:3680
  s_waitcnt vmcnt(10)
  s_waitcnt lgkmcnt(6)
  v_mfma_f32_16x16x32_bf16 v[144:147], v[200:203], v[32:35], 0
  v_mfma_f32_16x16x32_bf16 v[148:151], v[200:203], v[36:39], 0
  ds_read_b64_tr_b16 v[200:201], v22 offset:7168
  ds_read_b64_tr_b16 v[202:203], v22 offset:10752
  s_waitcnt lgkmcnt(6)
  v_mfma_f32_16x16x32_bf16 v[152:155], v[204:207], v[32:35], 0
  v_mfma_f32_16x16x32_bf16 v[156:159], v[204:207], v[36:39], 0
  ds_read_b64_tr_b16 v[204:205], v22 offset:7200
  ds_read_b64_tr_b16 v[206:207], v22 offset:10784
  s_add_u32 s72, s80, 4096
  buffer_load_dwordx4 v[72:75], v238, s[60:63], s72 offen offset:1024 sc1
  s_add_u32 s72, s80, 16384
  buffer_load_dwordx4 v[76:79], v238, s[60:63], s72 offen offset:3072 sc1
  s_waitcnt lgkmcnt(6)
  v_mfma_f32_16x16x32_bf16 v[160:163], v[208:211], v[32:35], 0
  v_mfma_f32_16x16x32_bf16 v[164:167], v[208:211], v[36:39], 0
  ds_read_b64_tr_b16 v[208:209], v22 offset:7232
  ds_read_b64_tr_b16 v[210:211], v22 offset:10816
  s_waitcnt lgkmcnt(6)
  v_mfma_f32_16x16x32_bf16 v[168:171], v[212:215], v[32:35], 0
  v_mfma_f32_16x16x32_bf16 v[172:175], v[212:215], v[36:39], 0
  ds_read_b64_tr_b16 v[212:213], v22 offset:7264
  ds_read_b64_tr_b16 v[214:215], v22 offset:10848
  s_waitcnt vmcnt(8)
  s_waitcnt lgkmcnt(6)
  v_mfma_f32_16x16x32_bf16 v[144:147], v[200:203], v[40:43], v[144:147]
  v_mfma_f32_16x16x32_bf16 v[148:151], v[200:203], v[44:47], v[148:151]
  ds_read_b64_tr_b16 v[200:201], v22 offset:14336
  ds_read_b64_tr_b16 v[202:203], v22 offset:17920
  s_waitcnt lgkmcnt(6)
  v_mfma_f32_16x16x32_bf16 v[152:155], v[204:207], v[40:43], v[152:155]
  v_mfma_f32_16x16x32_bf16 v[156:159], v[204:207], v[44:47], v[156:159]
  ds_read_b64_tr_b16 v[204:205], v22 offset:14368
  ds_read_b64_tr_b16 v[206:207], v22 offset:17952
  s_add_u32 s72, s80, 4096
  buffer_load_dwordx4 v[80:83], v238, s[60:63], s72 offen offset:2048 sc1
  s_add_u32 s72, s80, 20480
  buffer_load_dwordx4 v[84:87], v238, s[60:63], s72 offen offset:0 sc1
  s_waitcnt lgkmcnt(6)
  v_mfma_f32_16x16x32_bf16 v[160:163], v[208:211], v[40:43], v[160:163]
  v_mfma_f32_16x16x32_bf16 v[164:167], v[208:211], v[44:47], v[164:167]
  ds_read_b64_tr_b16 v[208:209], v22 offset:14400
  ds_read_b64_tr_b16 v[210:211], v22 offset:17984
  s_waitcnt lgkmcnt(6)
  v_mfma_f32_16x16x32_bf16 v[168:171], v[212:215], v[40:43], v[168:171]
  v_mfma_f32_16x16x32_bf16 v[172:175], v[212:215], v[44:47], v[172:175]
  ds_read_b64_tr_b16 v[212:213], v22 offset:14432
  ds_read_b64_tr_b16 v[214:215], v22 offset:18016
  s_waitcnt vmcnt(8)
  s_waitcnt lgkmcnt(6)
  v_mfma_f32_16x16x32_bf16 v[144:147], v[200:203], v[48:51], v[144:147]
  v_mfma_f32_16x16x32_bf16 v[148:151], v[200:203], v[52:55], v[148:151]
  ds_read_b64_tr_b16 v[200:201], v22 offset:21504
  ds_read_b64_tr_b16 v[202:203], v22 offset:25088
  s_waitcnt lgkmcnt(6)
  v_mfma_f32_16x16x32_bf16 v[152:155], v[204:207], v[48:51], v[152:155]
  v_mfma_f32_16x16x32_bf16 v[156:159], v[204:207], v[52:55], v[156:159]
  ds_read_b64_tr_b16 v[204:205], v22 offset:21536
  ds_read_b64_tr_b16 v[206:207], v22 offset:25120
  s_add_u32 s72, s80, 4096
  buffer_load_dwordx4 v[88:91], v238, s[60:63], s72 offen offset:3072 sc1
  s_add_u32 s72, s80, 20480
  buffer_load_dwordx4 v[92:95], v238, s[60:63], s72 offen offset:1024 sc1
  s_waitcnt lgkmcnt(6)
  v_mfma_f32_16x16x32_bf16 v[160:163], v[208:211], v[48:51], v[160:163]
  v_mfma_f32_16x16x32_bf16 v[164:167], v[208:211], v[52:55], v[164:167]
  ds_read_b64_tr_b16 v[208:209], v22 offset:21568
  ds_read_b64_tr_b16 v[210:211], v22 offset:25152
  s_waitcnt lgkmcnt(6)
  v_mfma_f32_16x16x32_bf16 v[168:171], v[212:215], v[48:51], v[168:171]
  v_mfma_f32_16x16x32_bf16 v[172:175], v[212:215], v[52:55], v[172:175]
  ds_read_b64_tr_b16 v[212:213], v22 offset:21600
  ds_read_b64_tr_b16 v[214:215], v22 offset:25184
  s_waitcnt vmcnt(8)
  s_waitcnt lgkmcnt(6)
  v_mfma_f32_16x16x32_bf16 v[144:147], v[200:203], v[56:59], v[144:147]
  v_mfma_f32_16x16x32_bf16 v[148:151], v[200:203], v[60:63], v[148:151]
  ds_read_b64_tr_b16 v[200:201], v22 offset:28672
  ds_read_b64_tr_b16 v[202:203], v22 offset:32256
  s_waitcnt lgkmcnt(6)
  v_mfma_f32_16x16x32_bf16 v[152:155], v[204:207], v[56:59], v[152:155]
  v_mfma_f32_16x16x32_bf16 v[156:159], v[204:207], v[60:63], v[156:159]
  ds_read_b64_tr_b16 v[204:205], v22 offset:28704
  ds_read_b64_tr_b16 v[206:207], v22 offset:32288
  s_add_u32 s72, s80, 8192
  buffer_load_dwordx4 v[96:99], v238, s[60:63], s72 offen offset:0 sc1
  s_add_u32 s72, s80, 20480
  buffer_load_dwordx4 v[100:103], v238, s[60:63], s72 offen offset:2048 sc1
  s_waitcnt lgkmcnt(6)
  v_mfma_f32_16x16x32_bf16 v[160:163], v[208:211], v[56:59], v[160:163]
  v_mfma_f32_16x16x32_bf16 v[164:167], v[208:211], v[60:63], v[164:167]
  ds_read_b64_tr_b16 v[208:209], v22 offset:28736
  ds_read_b64_tr_b16 v[210:211], v22 offset:32320
  s_waitcnt lgkmcnt(6)
  v_mfma_f32_16x16x32_bf16 v[168:171], v[212:215], v[56:59], v[168:171]
  v_mfma_f32_16x16x32_bf16 v[172:175], v[212:215], v[60:63], v[172:175]
  ds_read_b64_tr_b16 v[212:213], v22 offset:28768
  ds_read_b64_tr_b16 v[214:215], v22 offset:32352
  s_waitcnt vmcnt(8)
  s_waitcnt lgkmcnt(6)
  v_mfma_f32_16x16x32_bf16 v[144:147], v[200:203], v[64:67], v[144:147]
  v_mfma_f32_16x16x32_bf16 v[148:151], v[200:203], v[68:71], v[148:151]
  ds_read_b64_tr_b16 v[200:201], v22 offset:35840
  ds_read_b64_tr_b16 v[202:203], v22 offset:39424
  s_waitcnt lgkmcnt(6)
  v_mfma_f32_16x16x32_bf16 v[152:155], v[204:207], v[64:67], v[152:155]
  v_mfma_f32_16x16x32_bf16 v[156:159], v[204:207], v[68:71], v[156:159]
  ds_read_b64_tr_b16 v[204:205], v22 offset:35872
  ds_read_b64_tr_b16 v[206:207], v22 offset:39456
  s_add_u32 s72, s80, 8192
  buffer_load_dwordx4 v[104:107], v238, s[60:63], s72 offen offset:1024 sc1
  s_add_u32 s72, s80, 20480
  buffer_load_dwordx4 v[108:111], v238, s[60:63], s72 offen offset:3072 sc1
  s_waitcnt lgkmcnt(6)
  v_mfma_f32_16x16x32_bf16 v[160:163], v[208:211], v[64:67], v[160:163]
  v_mfma_f32_16x16x32_bf16 v[164:167], v[208:211], v[68:71], v[164:167]
  ds_read_b64_tr_b16 v[208:209], v22 offset:35904
  ds_read_b64_tr_b16 v[210:211], v22 offset:39488
  s_waitcnt lgkmcnt(6)
  v_mfma_f32_16x16x32_bf16 v[168:171], v[212:215], v[64:67], v[168:171]
  v_mfma_f32_16x16x32_bf16 v[172:175], v[212:215], v[68:71], v[172:175]
  ds_read_b64_tr_b16 v[212:213], v22 offset:35936
  ds_read_b64_tr_b16 v[214:215], v22 offset:39520
  s_waitcnt vmcnt(8)
  s_waitcnt lgkmcnt(6)
  v_mfma_f32_16x16x32_bf16 v[144:147], v[200:203], v[72:75], v[144:147]
  v_mfma_f32_16x16x32_bf16 v[148:151], v[200:203], v[76:79], v[148:151]
  ds_read_b64_tr_b16 v[200:201], v22 offset:43008
  ds_read_b64_tr_b16 v[202:203], v22 offset:46592
  s_waitcnt lgkmcnt(6)
  v_mfma_f32_16x16x32_bf16 v[152:155], v[204:207], v[72:75], v[152:155]
  v_mfma_f32_16x16x32_bf16 v[156:159], v[204:207], v[76:79], v[156:159]
  ds_read_b64_tr_b16 v[204:205], v22 offset:43040
  ds_read_b64_tr_b16 v[206:207], v22 offset:46624
  s_add_u32 s72, s80, 8192
  buffer_load_dwordx4 v[112:115], v238, s[60:63], s72 offen offset:2048 sc1
  s_add_u32 s72, s80, 24576
  buffer_load_dwordx4 v[116:119], v238, s[60:63], s72 offen offset:0 sc1
  s_waitcnt lgkmcnt(6)
  v_mfma_f32_16x16x32_bf16 v[160:163], v[208:211], v[72:75], v[160:163]
  v_mfma_f32_16x16x32_bf16 v[164:167], v[208:211], v[76:79], v[164:167]
  ds_read_b64_tr_b16 v[208:209], v22 offset:43072
  ds_read_b64_tr_b16 v[210:211], v22 offset:46656
  s_waitcnt lgkmcnt(6)
  v_mfma_f32_16x16x32_bf16 v[168:171], v[212:215], v[72:75], v[168:171]
  v_mfma_f32_16x16x32_bf16 v[172:175], v[212:215], v[76:79], v[172:175]
  ds_read_b64_tr_b16 v[212:213], v22 offset:43104
  ds_read_b64_tr_b16 v[214:215], v22 offset:46688
  s_waitcnt vmcnt(8)
  s_waitcnt lgkmcnt(6)
  v_mfma_f32_16x16x32_bf16 v[144:147], v[200:203], v[80:83], v[144:147]
  v_mfma_f32_16x16x32_bf16 v[148:151], v[200:203], v[84:87], v[148:151]
  ds_read_b64_tr_b16 v[200:201], v22 offset:50176
  ds_read_b64_tr_b16 v[202:203], v22 offset:53760
  s_waitcnt lgkmcnt(6)
  v_mfma_f32_16x16x32_bf16 v[152:155], v[204:207], v[80:83], v[152:155]
  v_mfma_f32_16x16x32_bf16 v[156:159], v[204:207], v[84:87], v[156:159]
  ds_read_b64_tr_b16 v[204:205], v22 offset:50208
  ds_read_b64_tr_b16 v[206:207], v22 offset:53792
  s_add_u32 s72, s80, 8192
  buffer_load_dwordx4 v[120:123], v238, s[60:63], s72 offen offset:3072 sc1
  s_add_u32 s72, s80, 24576
  buffer_load_dwordx4 v[124:127], v238, s[60:63], s72 offen offset:1024 sc1
  s_waitcnt lgkmcnt(6)
  v_mfma_f32_16x16x32_bf16 v[160:163], v[208:211], v[80:83], v[160:163]
  v_mfma_f32_16x16x32_bf16 v[164:167], v[208:211], v[84:87], v[164:167]
  ds_read_b64_tr_b16 v[208:209], v22 offset:50240
  ds_read_b64_tr_b16 v[210:211], v22 offset:53824
  s_waitcnt lgkmcnt(6)
  v_mfma_f32_16x16x32_bf16 v[168:171], v[212:215], v[80:83], v[168:171]
  v_mfma_f32_16x16x32_bf16 v[172:175], v[212:215], v[84:87], v[172:175]
  ds_read_b64_tr_b16 v[212:213], v22 offset:50272
  ds_read_b64_tr_b16 v[214:215], v22 offset:53856
  s_waitcnt vmcnt(8)
  s_waitcnt lgkmcnt(6)
  v_mfma_f32_16x16x32_bf16 v[144:147], v[200:203], v[88:91], v[144:147]
  v_mfma_f32_16x16x32_bf16 v[148:151], v[200:203], v[92:95], v[148:151]
  ds_read_b64_tr_b16 v[200:201], v23 offset:0
  ds_read_b64_tr_b16 v[202:203], v23 offset:3584
  s_waitcnt lgkmcnt(6)
  v_mfma_f32_16x16x32_bf16 v[152:155], v[204:207], v[88:91], v[152:155]
  v_mfma_f32_16x16x32_bf16 v[156:159], v[204:207], v[92:95], v[156:159]
  ds_read_b64_tr_b16 v[204:205], v23 offset:32
  ds_read_b64_tr_b16 v[206:207], v23 offset:3616
  s_add_u32 s72, s80, 12288
  buffer_load_dwordx4 v[128:131], v238, s[60:63], s72 offen offset:0 sc1
  s_add_u32 s72, s80, 24576
  buffer_load_dwordx4 v[132:135], v238, s[60:63], s72 offen offset:2048 sc1
  s_waitcnt lgkmcnt(6)
  v_mfma_f32_16x16x32_bf16 v[160:163], v[208:211], v[88:91], v[160:163]
  v_mfma_f32_16x16x32_bf16 v[164:167], v[208:211], v[92:95], v[164:167]
  ds_read_b64_tr_b16 v[208:209], v23 offset:64
  ds_read_b64_tr_b16 v[210:211], v23 offset:3648
  s_waitcnt lgkmcnt(6)
  v_mfma_f32_16x16x32_bf16 v[168:171], v[212:215], v[88:91], v[168:171]
  v_mfma_f32_16x16x32_bf16 v[172:175], v[212:215], v[92:95], v[172:175]
  ds_read_b64_tr_b16 v[212:213], v23 offset:96
  ds_read_b64_tr_b16 v[214:215], v23 offset:3680
  v_cndmask_b32 v222, v222, 0, s[82:83]
  v_cndmask_b32 v223, v223, 0, s[82:83]
  v_add_f32 v220, v220, v222
  v_add_f32 v221, v221, v223
  v_mov_b32 v222, v220
  s_nop 1
  v_permlane32_swap_b32 v220, v222
  v_add_f32 v220, v220, v222
  v_mov_b32 v222, v220
  s_nop 1
  v_permlane16_swap_b32 v220, v222
  v_add_f32 v220, v220, v222
  v_mov_b32 v222, v221
  s_nop 1
  v_permlane32_swap_b32 v221, v222
  v_add_f32 v221, v221, v222
  v_mov_b32 v222, v221
  s_nop 1
  v_permlane16_swap_b32 v221, v222
  v_add_f32 v221, v221, v222
  v_mul_f32 v14, 0x3b124925, v220
  v_mul_f32 v221, 0x3b124925, v221
  v_fma_f32 v221, -v14, v14, v221
  v_max_f32 v221, 0, v221
  v_add_f32 v221, 0x3727c5ac, v221
  v_rsq_f32 v16, v221
  v_sub_f32 v220, 0, v14
  v_cvt_pk_bf16_f32 v221, v220, v220
  v_lshlrev_b32 v221, 16, v221
  v_sub_f32 v221, v220, v221
  v_cvt_pk_bf16_f32 v222, v220, v221
  v_cndmask_b32 v222, v222, 0, s[86:87]
  v_mov_b32 v220, v222
  v_mov_b32 v221, v222
  v_mov_b32 v222, 0
  v_mov_b32 v223, 0
  v_mov_b32 v24, 0
  v_mov_b32 v25, 0
  v_mov_b32 v26, v220
  v_mov_b32 v27, v220
  v_cndmask_b32 v226, v226, 0, s[82:83]
  v_cndmask_b32 v227, v227, 0, s[82:83]
  v_add_f32 v224, v224, v226
  v_add_f32 v225, v225, v227
  v_mov_b32 v226, v224
  s_nop 1
  v_permlane32_swap_b32 v224, v226
  v_add_f32 v224, v224, v226
  v_mov_b32 v226, v224
  s_nop 1
  v_permlane16_swap_b32 v224, v226
  v_add_f32 v224, v224, v226
  v_mov_b32 v226, v225
  s_nop 1
  v_permlane32_swap_b32 v225, v226
  v_add_f32 v225, v225, v226
  v_mov_b32 v226, v225
  s_nop 1
  v_permlane16_swap_b32 v225, v226
  v_add_f32 v225, v225, v226
  v_mul_f32 v15, 0x3b124925, v224
  v_mul_f32 v225, 0x3b124925, v225
  v_fma_f32 v225, -v15, v15, v225
  v_max_f32 v225, 0, v225
  v_add_f32 v225, 0x3727c5ac, v225
  v_rsq_f32 v17, v225
  v_sub_f32 v224, 0, v15
  v_cvt_pk_bf16_f32 v225, v224, v224
  v_lshlrev_b32 v225, 16, v225
  v_sub_f32 v225, v224, v225
  v_cvt_pk_bf16_f32 v226, v224, v225
  v_cndmask_b32 v226, v226, 0, s[86:87]
  v_mov_b32 v224, v226
  v_mov_b32 v225, v226
  v_mov_b32 v226, 0
  v_mov_b32 v227, 0
  v_mov_b32 v28, 0
  v_mov_b32 v29, 0
  v_mov_b32 v30, v224
  v_mov_b32 v31, v224
  s_waitcnt vmcnt(8)
  s_waitcnt lgkmcnt(6)
  v_mfma_f32_16x16x32_bf16 v[144:147], v[200:203], v[96:99], v[144:147]
  v_mfma_f32_16x16x32_bf16 v[148:151], v[200:203], v[100:103], v[148:151]
  ds_read_b64_tr_b16 v[200:201], v23 offset:7168
  ds_read_b64_tr_b16 v[202:203], v23 offset:10752
  s_waitcnt lgkmcnt(6)
  v_mfma_f32_16x16x32_bf16 v[152:155], v[204:207], v[96:99], v[152:155]
  v_mfma_f32_16x16x32_bf16 v[156:159], v[204:207], v[100:103], v[156:159]
  ds_read_b64_tr_b16 v[204:205], v23 offset:7200
  ds_read_b64_tr_b16 v[206:207], v23 offset:10784
  s_add_u32 s72, s80, 12288
  buffer_load_dwordx4 v[136:139], v238, s[60:63], s72 offen offset:1024 sc1
  s_add_u32 s72, s80, 24576
  buffer_load_dwordx4 v[140:143], v238, s[60:63], s72 offen offset:3072 sc1
  s_waitcnt lgkmcnt(6)
  v_mfma_f32_16x16x32_bf16 v[160:163], v[208:211], v[96:99], v[160:163]
  v_mfma_f32_16x16x32_bf16 v[164:167], v[208:211], v[100:103], v[164:167]
  ds_read_b64_tr_b16 v[208:209], v23 offset:7232
  ds_read_b64_tr_b16 v[210:211], v23 offset:10816
  s_waitcnt lgkmcnt(6)
  v_mfma_f32_16x16x32_bf16 v[168:171], v[212:215], v[96:99], v[168:171]
  v_mfma_f32_16x16x32_bf16 v[172:175], v[212:215], v[100:103], v[172:175]
  ds_read_b64_tr_b16 v[212:213], v23 offset:7264
  ds_read_b64_tr_b16 v[214:215], v23 offset:10848
  s_waitcnt vmcnt(8)
  s_waitcnt lgkmcnt(6)
  v_mfma_f32_16x16x32_bf16 v[144:147], v[200:203], v[104:107], v[144:147]
  v_mfma_f32_16x16x32_bf16 v[148:151], v[200:203], v[108:111], v[148:151]
  ds_read_b64_tr_b16 v[200:201], v23 offset:14336
  ds_read_b64_tr_b16 v[202:203], v23 offset:17920
  s_waitcnt lgkmcnt(6)
  v_mfma_f32_16x16x32_bf16 v[152:155], v[204:207], v[104:107], v[152:155]
  v_mfma_f32_16x16x32_bf16 v[156:159], v[204:207], v[108:111], v[156:159]
  ds_read_b64_tr_b16 v[204:205], v23 offset:14368
  ds_read_b64_tr_b16 v[206:207], v23 offset:17952
  s_waitcnt lgkmcnt(6)
  v_mfma_f32_16x16x32_bf16 v[160:163], v[208:211], v[104:107], v[160:163]
  v_mfma_f32_16x16x32_bf16 v[164:167], v[208:211], v[108:111], v[164:167]
  ds_read_b64_tr_b16 v[208:209], v23 offset:14400
  ds_read_b64_tr_b16 v[210:211], v23 offset:17984
  s_waitcnt lgkmcnt(6)
  v_mfma_f32_16x16x32_bf16 v[168:171], v[212:215], v[104:107], v[168:171]
  v_mfma_f32_16x16x32_bf16 v[172:175], v[212:215], v[108:111], v[172:175]
  ds_read_b64_tr_b16 v[212:213], v23 offset:14432
  ds_read_b64_tr_b16 v[214:215], v23 offset:18016
  s_waitcnt vmcnt(6)
  s_waitcnt lgkmcnt(6)
  v_mfma_f32_16x16x32_bf16 v[144:147], v[200:203], v[112:115], v[144:147]
  v_mfma_f32_16x16x32_bf16 v[148:151], v[200:203], v[116:119], v[148:151]
  ds_read_b64_tr_b16 v[200:201], v23 offset:21504
  ds_read_b64_tr_b16 v[202:203], v23 offset:25088
  s_waitcnt lgkmcnt(6)
  v_mfma_f32_16x16x32_bf16 v[152:155], v[204:207], v[112:115], v[152:155]
  v_mfma_f32_16x16x32_bf16 v[156:159], v[204:207], v[116:119], v[156:159]
  ds_read_b64_tr_b16 v[204:205], v23 offset:21536
  ds_read_b64_tr_b16 v[206:207], v23 offset:25120
  s_waitcnt lgkmcnt(6)
  v_mfma_f32_16x16x32_bf16 v[160:163], v[208:211], v[112:115], v[160:163]
  v_mfma_f32_16x16x32_bf16 v[164:167], v[208:211], v[116:119], v[164:167]
  ds_read_b64_tr_b16 v[208:209], v23 offset:21568
  ds_read_b64_tr_b16 v[210:211], v23 offset:25152
  s_waitcnt lgkmcnt(6)
  v_mfma_f32_16x16x32_bf16 v[168:171], v[212:215], v[112:115], v[168:171]
  v_mfma_f32_16x16x32_bf16 v[172:175], v[212:215], v[116:119], v[172:175]
  ds_read_b64_tr_b16 v[212:213], v23 offset:21600
  ds_read_b64_tr_b16 v[214:215], v23 offset:25184
  s_waitcnt vmcnt(4)
  s_waitcnt lgkmcnt(6)
  v_mfma_f32_16x16x32_bf16 v[144:147], v[200:203], v[120:123], v[144:147]
  v_mfma_f32_16x16x32_bf16 v[148:151], v[200:203], v[124:127], v[148:151]
  ds_read_b64_tr_b16 v[200:201], v23 offset:28672
  ds_read_b64_tr_b16 v[202:203], v23 offset:32256
  s_waitcnt lgkmcnt(6)
  v_mfma_f32_16x16x32_bf16 v[152:155], v[204:207], v[120:123], v[152:155]
  v_mfma_f32_16x16x32_bf16 v[156:159], v[204:207], v[124:127], v[156:159]
  ds_read_b64_tr_b16 v[204:205], v23 offset:28704
  ds_read_b64_tr_b16 v[206:207], v23 offset:32288
  s_waitcnt lgkmcnt(6)
  v_mfma_f32_16x16x32_bf16 v[160:163], v[208:211], v[120:123], v[160:163]
  v_mfma_f32_16x16x32_bf16 v[164:167], v[208:211], v[124:127], v[164:167]
  ds_read_b64_tr_b16 v[208:209], v23 offset:28736
  ds_read_b64_tr_b16 v[210:211], v23 offset:32320
  s_waitcnt lgkmcnt(6)
  v_mfma_f32_16x16x32_bf16 v[168:171], v[212:215], v[120:123], v[168:171]
  v_mfma_f32_16x16x32_bf16 v[172:175], v[212:215], v[124:127], v[172:175]
  ds_read_b64_tr_b16 v[212:213], v23 offset:28768
  ds_read_b64_tr_b16 v[214:215], v23 offset:32352
  s_waitcnt vmcnt(2)
  s_waitcnt lgkmcnt(6)
  v_mfma_f32_16x16x32_bf16 v[144:147], v[200:203], v[128:131], v[144:147]
  v_mfma_f32_16x16x32_bf16 v[148:151], v[200:203], v[132:135], v[148:151]
  ds_read_b64_tr_b16 v[200:201], v23 offset:35840
  ds_read_b64_tr_b16 v[202:203], v23 offset:39424
  s_waitcnt lgkmcnt(6)
  v_mfma_f32_16x16x32_bf16 v[152:155], v[204:207], v[128:131], v[152:155]
  v_mfma_f32_16x16x32_bf16 v[156:159], v[204:207], v[132:135], v[156:159]
  ds_read_b64_tr_b16 v[204:205], v23 offset:35872
  ds_read_b64_tr_b16 v[206:207], v23 offset:39456
  s_waitcnt lgkmcnt(6)
  v_mfma_f32_16x16x32_bf16 v[160:163], v[208:211], v[128:131], v[160:163]
  v_mfma_f32_16x16x32_bf16 v[164:167], v[208:211], v[132:135], v[164:167]
  ds_read_b64_tr_b16 v[208:209], v23 offset:35904
  ds_read_b64_tr_b16 v[210:211], v23 offset:39488
  s_waitcnt lgkmcnt(6)
  v_mfma_f32_16x16x32_bf16 v[168:171], v[212:215], v[128:131], v[168:171]
  v_mfma_f32_16x16x32_bf16 v[172:175], v[212:215], v[132:135], v[172:175]
  ds_read_b64_tr_b16 v[212:213], v23 offset:35936
  ds_read_b64_tr_b16 v[214:215], v23 offset:39520
  s_waitcnt vmcnt(0)
  s_waitcnt lgkmcnt(6)
  v_mfma_f32_16x16x32_bf16 v[144:147], v[200:203], v[136:139], v[144:147]
  v_mfma_f32_16x16x32_bf16 v[148:151], v[200:203], v[140:143], v[148:151]
  ds_read_b64_tr_b16 v[200:201], v22 offset:128
  ds_read_b64_tr_b16 v[202:203], v22 offset:3712
  s_waitcnt lgkmcnt(6)
  v_mfma_f32_16x16x32_bf16 v[152:155], v[204:207], v[136:139], v[152:155]
  v_mfma_f32_16x16x32_bf16 v[156:159], v[204:207], v[140:143], v[156:159]
  ds_read_b64_tr_b16 v[204:205], v22 offset:160
  ds_read_b64_tr_b16 v[206:207], v22 offset:3744
  s_waitcnt lgkmcnt(6)
  v_mfma_f32_16x16x32_bf16 v[160:163], v[208:211], v[136:139], v[160:163]
  v_mfma_f32_16x16x32_bf16 v[164:167], v[208:211], v[140:143], v[164:167]
  ds_read_b64_tr_b16 v[208:209], v22 offset:192
  ds_read_b64_tr_b16 v[210:211], v22 offset:3776
  s_waitcnt lgkmcnt(6)
  v_mfma_f32_16x16x32_bf16 v[168:171], v[212:215], v[136:139], v[168:171]
  v_mfma_f32_16x16x32_bf16 v[172:175], v[212:215], v[140:143], v[172:175]
  v_mfma_f32_16x16x32_bf16 v[144:147], v[240:243], v[220:223], v[144:147]
  v_mfma_f32_16x16x32_bf16 v[148:151], v[240:243], v[224:227], v[148:151]
  v_mfma_f32_16x16x32_bf16 v[152:155], v[242:245], v[220:223], v[152:155]
  v_mfma_f32_16x16x32_bf16 v[156:159], v[242:245], v[224:227], v[156:159]
  v_mfma_f32_16x16x32_bf16 v[160:163], v[244:247], v[220:223], v[160:163]
  v_mfma_f32_16x16x32_bf16 v[164:167], v[244:247], v[224:227], v[164:167]
  v_mfma_f32_16x16x32_bf16 v[168:171], v[246:249], v[220:223], v[168:171]
  v_mfma_f32_16x16x32_bf16 v[172:175], v[246:249], v[224:227], v[172:175]
  s_waitcnt lgkmcnt(4)
  v_mfma_f32_16x16x32_bf16 v[176:179], v[200:203], v[32:35], 0
  v_mfma_f32_16x16x32_bf16 v[180:183], v[200:203], v[36:39], 0
  ds_read_b64_tr_b16 v[200:201], v22 offset:7296
  ds_read_b64_tr_b16 v[202:203], v22 offset:10880
  s_waitcnt lgkmcnt(4)
  v_mfma_f32_16x16x32_bf16 v[184:187], v[204:207], v[32:35], 0
  v_mfma_f32_16x16x32_bf16 v[188:191], v[204:207], v[36:39], 0
  ds_read_b64_tr_b16 v[204:205], v22 offset:7328
  ds_read_b64_tr_b16 v[206:207], v22 offset:10912
  s_waitcnt lgkmcnt(4)
  v_mfma_f32_16x16x32_bf16 v[192:195], v[208:211], v[32:35], 0
  v_mfma_f32_16x16x32_bf16 v[196:199], v[208:211], v[36:39], 0
  ds_read_b64_tr_b16 v[208:209], v22 offset:7360
  ds_read_b64_tr_b16 v[210:211], v22 offset:10944
  v_accvgpr_read_b32 v5, a224
  v_accvgpr_read_b32 v6, a225
  v_accvgpr_read_b32 v7, a226
  v_accvgpr_read_b32 v8, a227
  v_fma_f32 v144, v144, v16, v5
  v_fma_f32 v145, v145, v16, v6
  v_fma_f32 v146, v146, v16, v7
  v_fma_f32 v147, v147, v16, v8
  v_max_f32 v144, 0, v144
  v_max_f32 v145, 0, v145
  v_max_f32 v146, 0, v146
  v_max_f32 v147, 0, v147
  v_mul_f32 v144, v144, v144
  v_mul_f32 v145, v145, v145
  v_mul_f32 v146, v146, v146
  v_mul_f32 v147, v147, v147
  v_cvt_pk_bf16_f32 v144, v144, v145
  v_cvt_pk_bf16_f32 v145, v146, v147
  v_accvgpr_read_b32 v5, a228
  v_accvgpr_read_b32 v6, a229
  v_accvgpr_read_b32 v7, a230
  v_accvgpr_read_b32 v8, a231
  v_fma_f32 v152, v152, v16, v5
  v_fma_f32 v153, v153, v16, v6
  v_fma_f32 v154, v154, v16, v7
  v_fma_f32 v155, v155, v16, v8
  v_max_f32 v152, 0, v152
  v_max_f32 v153, 0, v153
  v_max_f32 v154, 0, v154
  v_max_f32 v155, 0, v155
  v_mul_f32 v152, v152, v152
  v_mul_f32 v153, v153, v153
  v_mul_f32 v154, v154, v154
  v_mul_f32 v155, v155, v155
  v_cvt_pk_bf16_f32 v146, v152, v153
  v_cvt_pk_bf16_f32 v147, v154, v155
  s_waitcnt lgkmcnt(4)
  v_mfma_f32_16x16x32_bf16 v[176:179], v[200:203], v[40:43], v[176:179]
  v_mfma_f32_16x16x32_bf16 v[180:183], v[200:203], v[44:47], v[180:183]
  ds_read_b64_tr_b16 v[200:201], v22 offset:14464
  ds_read_b64_tr_b16 v[202:203], v22 offset:18048
  s_waitcnt lgkmcnt(4)
  v_mfma_f32_16x16x32_bf16 v[184:187], v[204:207], v[40:43], v[184:187]
  v_mfma_f32_16x16x32_bf16 v[188:191], v[204:207], v[44:47], v[188:191]
  ds_read_b64_tr_b16 v[204:205], v22 offset:14496
  ds_read_b64_tr_b16 v[206:207], v22 offset:18080
  s_waitcnt lgkmcnt(4)
  v_mfma_f32_16x16x32_bf16 v[192:195], v[208:211], v[40:43], v[192:195]
  v_mfma_f32_16x16x32_bf16 v[196:199], v[208:211], v[44:47], v[196:199]
  ds_read_b64_tr_b16 v[208:209], v22 offset:14528
  ds_read_b64_tr_b16 v[210:211], v22 offset:18112
  s_lshl_b32 s71, s88, 11
  s_add_u32 s71, s71, 0
  s_add_u32 s71, s71, s81
  buffer_store_dwordx4 v[144:147], v238, s[60:63], s71 offen sc1
  v_accvgpr_read_b32 v5, a224
  v_accvgpr_read_b32 v6, a225
  v_accvgpr_read_b32 v7, a226
  v_accvgpr_read_b32 v8, a227
  v_fma_f32 v148, v148, v17, v5
  v_fma_f32 v149, v149, v17, v6
  v_fma_f32 v150, v150, v17, v7
  v_fma_f32 v151, v151, v17, v8
  v_max_f32 v148, 0, v148
  v_max_f32 v149, 0, v149
  v_max_f32 v150, 0, v150
  v_max_f32 v151, 0, v151
  v_mul_f32 v148, v148, v148
  v_mul_f32 v149, v149, v149
  v_mul_f32 v150, v150, v150
  v_mul_f32 v151, v151, v151
  v_cvt_pk_bf16_f32 v148, v148, v149
  v_cvt_pk_bf16_f32 v149, v150, v151
  s_waitcnt lgkmcnt(4)
  v_mfma_f32_16x16x32_bf16 v[176:179], v[200:203], v[48:51], v[176:179]
  v_mfma_f32_16x16x32_bf16 v[180:183], v[200:203], v[52:55], v[180:183]
  ds_read_b64_tr_b16 v[200:201], v22 offset:21632
  ds_read_b64_tr_b16 v[202:203], v22 offset:25216
  s_waitcnt lgkmcnt(4)
  v_mfma_f32_16x16x32_bf16 v[184:187], v[204:207], v[48:51], v[184:187]
  v_mfma_f32_16x16x32_bf16 v[188:191], v[204:207], v[52:55], v[188:191]
  ds_read_b64_tr_b16 v[204:205], v22 offset:21664
  ds_read_b64_tr_b16 v[206:207], v22 offset:25248
  s_waitcnt lgkmcnt(4)
  v_mfma_f32_16x16x32_bf16 v[192:195], v[208:211], v[48:51], v[192:195]
  v_mfma_f32_16x16x32_bf16 v[196:199], v[208:211], v[52:55], v[196:199]
  ds_read_b64_tr_b16 v[208:209], v22 offset:21696
  ds_read_b64_tr_b16 v[210:211], v22 offset:25280
  v_accvgpr_read_b32 v5, a228
  v_accvgpr_read_b32 v6, a229
  v_accvgpr_read_b32 v7, a230
  v_accvgpr_read_b32 v8, a231
  v_fma_f32 v156, v156, v17, v5
  v_fma_f32 v157, v157, v17, v6
  v_fma_f32 v158, v158, v17, v7
  v_fma_f32 v159, v159, v17, v8
  v_max_f32 v156, 0, v156
  v_max_f32 v157, 0, v157
  v_max_f32 v158, 0, v158
  v_max_f32 v159, 0, v159
  v_mul_f32 v156, v156, v156
  v_mul_f32 v157, v157, v157
  v_mul_f32 v158, v158, v158
  v_mul_f32 v159, v159, v159
  v_cvt_pk_bf16_f32 v150, v156, v157
  v_cvt_pk_bf16_f32 v151, v158, v159
  s_lshl_b32 s71, s88, 11
  s_add_u32 s71, s71, 57344
  s_add_u32 s71, s71, s81
  buffer_store_dwordx4 v[148:151], v238, s[60:63], s71 offen sc1
  s_waitcnt lgkmcnt(4)
  v_mfma_f32_16x16x32_bf16 v[176:179], v[200:203], v[56:59], v[176:179]
  v_mfma_f32_16x16x32_bf16 v[180:183], v[200:203], v[60:63], v[180:183]
  ds_read_b64_tr_b16 v[200:201], v22 offset:28800
  ds_read_b64_tr_b16 v[202:203], v22 offset:32384
  s_waitcnt lgkmcnt(4)
  v_mfma_f32_16x16x32_bf16 v[184:187], v[204:207], v[56:59], v[184:187]
  v_mfma_f32_16x16x32_bf16 v[188:191], v[204:207], v[60:63], v[188:191]
  ds_read_b64_tr_b16 v[204:205], v22 offset:28832
  ds_read_b64_tr_b16 v[206:207], v22 offset:32416
  s_waitcnt lgkmcnt(4)
  v_mfma_f32_16x16x32_bf16 v[192:195], v[208:211], v[56:59], v[192:195]
  v_mfma_f32_16x16x32_bf16 v[196:199], v[208:211], v[60:63], v[196:199]
  ds_read_b64_tr_b16 v[208:209], v22 offset:28864
  ds_read_b64_tr_b16 v[210:211], v22 offset:32448
  v_accvgpr_read_b32 v5, a232
  v_accvgpr_read_b32 v6, a233
  v_accvgpr_read_b32 v7, a234
  v_accvgpr_read_b32 v8, a235
  v_fma_f32 v160, v160, v16, v5
  v_fma_f32 v161, v161, v16, v6
  v_fma_f32 v162, v162, v16, v7
  v_fma_f32 v163, v163, v16, v8
  v_max_f32 v160, 0, v160
  v_max_f32 v161, 0, v161
  v_max_f32 v162, 0, v162
  v_max_f32 v163, 0, v163
  v_mul_f32 v160, v160, v160
  v_mul_f32 v161, v161, v161
  v_mul_f32 v162, v162, v162
  v_mul_f32 v163, v163, v163
  v_cvt_pk_bf16_f32 v160, v160, v161
  v_cvt_pk_bf16_f32 v161, v162, v163
  v_accvgpr_read_b32 v5, a236
  v_accvgpr_read_b32 v6, a237
  v_accvgpr_read_b32 v7, a238
  v_accvgpr_read_b32 v8, a239
  v_fma_f32 v168, v168, v16, v5
  v_fma_f32 v169, v169, v16, v6
  v_fma_f32 v170, v170, v16, v7
  v_fma_f32 v171, v171, v16, v8
  v_max_f32 v168, 0, v168
  v_max_f32 v169, 0, v169
  v_max_f32 v170, 0, v170
  v_max_f32 v171, 0, v171
  v_mul_f32 v168, v168, v168
  v_mul_f32 v169, v169, v169
  v_mul_f32 v170, v170, v170
  v_mul_f32 v171, v171, v171
  v_cvt_pk_bf16_f32 v162, v168, v169
  v_cvt_pk_bf16_f32 v163, v170, v171
  s_waitcnt lgkmcnt(4)
  v_mfma_f32_16x16x32_bf16 v[176:179], v[200:203], v[64:67], v[176:179]
  v_mfma_f32_16x16x32_bf16 v[180:183], v[200:203], v[68:71], v[180:183]
  ds_read_b64_tr_b16 v[200:201], v22 offset:35968
  ds_read_b64_tr_b16 v[202:203], v22 offset:39552
  s_waitcnt lgkmcnt(4)
  v_mfma_f32_16x16x32_bf16 v[184:187], v[204:207], v[64:67], v[184:187]
  v_mfma_f32_16x16x32_bf16 v[188:191], v[204:207], v[68:71], v[188:191]
  ds_read_b64_tr_b16 v[204:205], v22 offset:36000
  ds_read_b64_tr_b16 v[206:207], v22 offset:39584
  s_waitcnt lgkmcnt(4)
  v_mfma_f32_16x16x32_bf16 v[192:195], v[208:211], v[64:67], v[192:195]
  v_mfma_f32_16x16x32_bf16 v[196:199], v[208:211], v[68:71], v[196:199]
  ds_read_b64_tr_b16 v[208:209], v22 offset:36032
  ds_read_b64_tr_b16 v[210:211], v22 offset:39616
  s_lshl_b32 s71, s88, 11
  s_add_u32 s71, s71, 1024
  s_add_u32 s71, s71, s81
  buffer_store_dwordx4 v[160:163], v238, s[60:63], s71 offen sc1
  v_accvgpr_read_b32 v5, a232
  v_accvgpr_read_b32 v6, a233
  v_accvgpr_read_b32 v7, a234
  v_accvgpr_read_b32 v8, a235
  v_fma_f32 v164, v164, v17, v5
  v_fma_f32 v165, v165, v17, v6
  v_fma_f32 v166, v166, v17, v7
  v_fma_f32 v167, v167, v17, v8
  v_max_f32 v164, 0, v164
  v_max_f32 v165, 0, v165
  v_max_f32 v166, 0, v166
  v_max_f32 v167, 0, v167
  v_mul_f32 v164, v164, v164
  v_mul_f32 v165, v165, v165
  v_mul_f32 v166, v166, v166
  v_mul_f32 v167, v167, v167
  v_cvt_pk_bf16_f32 v164, v164, v165
  v_cvt_pk_bf16_f32 v165, v166, v167
  s_waitcnt lgkmcnt(4)
  v_mfma_f32_16x16x32_bf16 v[176:179], v[200:203], v[72:75], v[176:179]
  v_mfma_f32_16x16x32_bf16 v[180:183], v[200:203], v[76:79], v[180:183]
  ds_read_b64_tr_b16 v[200:201], v22 offset:43136
  ds_read_b64_tr_b16 v[202:203], v22 offset:46720
  s_waitcnt lgkmcnt(4)
  v_mfma_f32_16x16x32_bf16 v[184:187], v[204:207], v[72:75], v[184:187]
  v_mfma_f32_16x16x32_bf16 v[188:191], v[204:207], v[76:79], v[188:191]
  ds_read_b64_tr_b16 v[204:205], v22 offset:43168
  ds_read_b64_tr_b16 v[206:207], v22 offset:46752
  s_waitcnt lgkmcnt(4)
  v_mfma_f32_16x16x32_bf16 v[192:195], v[208:211], v[72:75], v[192:195]
  v_mfma_f32_16x16x32_bf16 v[196:199], v[208:211], v[76:79], v[196:199]
  ds_read_b64_tr_b16 v[208:209], v22 offset:43200
  ds_read_b64_tr_b16 v[210:211], v22 offset:46784
  v_accvgpr_read_b32 v5, a236
  v_accvgpr_read_b32 v6, a237
  v_accvgpr_read_b32 v7, a238
  v_accvgpr_read_b32 v8, a239
  v_fma_f32 v172, v172, v17, v5
  v_fma_f32 v173, v173, v17, v6
  v_fma_f32 v174, v174, v17, v7
  v_fma_f32 v175, v175, v17, v8
  v_max_f32 v172, 0, v172
  v_max_f32 v173, 0, v173
  v_max_f32 v174, 0, v174
  v_max_f32 v175, 0, v175
  v_mul_f32 v172, v172, v172
  v_mul_f32 v173, v173, v173
  v_mul_f32 v174, v174, v174
  v_mul_f32 v175, v175, v175
  v_cvt_pk_bf16_f32 v166, v172, v173
  v_cvt_pk_bf16_f32 v167, v174, v175
  s_lshl_b32 s71, s88, 11
  s_add_u32 s71, s71, 58368
  s_add_u32 s71, s71, s81
  buffer_store_dwordx4 v[164:167], v238, s[60:63], s71 offen sc1
  s_waitcnt lgkmcnt(4)
  v_mfma_f32_16x16x32_bf16 v[176:179], v[200:203], v[80:83], v[176:179]
  v_mfma_f32_16x16x32_bf16 v[180:183], v[200:203], v[84:87], v[180:183]
  ds_read_b64_tr_b16 v[200:201], v22 offset:50304
  ds_read_b64_tr_b16 v[202:203], v22 offset:53888
  s_waitcnt lgkmcnt(4)
  v_mfma_f32_16x16x32_bf16 v[184:187], v[204:207], v[80:83], v[184:187]
  v_mfma_f32_16x16x32_bf16 v[188:191], v[204:207], v[84:87], v[188:191]
  ds_read_b64_tr_b16 v[204:205], v22 offset:50336
  ds_read_b64_tr_b16 v[206:207], v22 offset:53920
  s_waitcnt lgkmcnt(4)
  v_mfma_f32_16x16x32_bf16 v[192:195], v[208:211], v[80:83], v[192:195]
  v_mfma_f32_16x16x32_bf16 v[196:199], v[208:211], v[84:87], v[196:199]
  ds_read_b64_tr_b16 v[208:209], v22 offset:50368
  ds_read_b64_tr_b16 v[210:211], v22 offset:53952
  s_waitcnt lgkmcnt(4)
  v_mfma_f32_16x16x32_bf16 v[176:179], v[200:203], v[88:91], v[176:179]
  v_mfma_f32_16x16x32_bf16 v[180:183], v[200:203], v[92:95], v[180:183]
  ds_read_b64_tr_b16 v[200:201], v23 offset:128
  ds_read_b64_tr_b16 v[202:203], v23 offset:3712
  s_waitcnt lgkmcnt(4)
  v_mfma_f32_16x16x32_bf16 v[184:187], v[204:207], v[88:91], v[184:187]
  v_mfma_f32_16x16x32_bf16 v[188:191], v[204:207], v[92:95], v[188:191]
  ds_read_b64_tr_b16 v[204:205], v23 offset:160
  ds_read_b64_tr_b16 v[206:207], v23 offset:3744
  s_waitcnt lgkmcnt(4)
  v_mfma_f32_16x16x32_bf16 v[192:195], v[208:211], v[88:91], v[192:195]
  v_mfma_f32_16x16x32_bf16 v[196:199], v[208:211], v[92:95], v[196:199]
  ds_read_b64_tr_b16 v[208:209], v23 offset:192
  ds_read_b64_tr_b16 v[210:211], v23 offset:3776
  s_waitcnt lgkmcnt(4)
  v_mfma_f32_16x16x32_bf16 v[176:179], v[200:203], v[96:99], v[176:179]
  v_mfma_f32_16x16x32_bf16 v[180:183], v[200:203], v[100:103], v[180:183]
  ds_read_b64_tr_b16 v[200:201], v23 offset:7296
  ds_read_b64_tr_b16 v[202:203], v23 offset:10880
  s_waitcnt lgkmcnt(4)
  v_mfma_f32_16x16x32_bf16 v[184:187], v[204:207], v[96:99], v[184:187]
  v_mfma_f32_16x16x32_bf16 v[188:191], v[204:207], v[100:103], v[188:191]
  ds_read_b64_tr_b16 v[204:205], v23 offset:7328
  ds_read_b64_tr_b16 v[206:207], v23 offset:10912
  s_waitcnt lgkmcnt(4)
  v_mfma_f32_16x16x32_bf16 v[192:195], v[208:211], v[96:99], v[192:195]
  v_mfma_f32_16x16x32_bf16 v[196:199], v[208:211], v[100:103], v[196:199]
  ds_read_b64_tr_b16 v[208:209], v23 offset:7360
  ds_read_b64_tr_b16 v[210:211], v23 offset:10944
  s_waitcnt lgkmcnt(4)
  v_mfma_f32_16x16x32_bf16 v[176:179], v[200:203], v[104:107], v[176:179]
  v_mfma_f32_16x16x32_bf16 v[180:183], v[200:203], v[108:111], v[180:183]
  ds_read_b64_tr_b16 v[200:201], v23 offset:14464
  ds_read_b64_tr_b16 v[202:203], v23 offset:18048
  s_waitcnt lgkmcnt(4)
  v_mfma_f32_16x16x32_bf16 v[184:187], v[204:207], v[104:107], v[184:187]
  v_mfma_f32_16x16x32_bf16 v[188:191], v[204:207], v[108:111], v[188:191]
  ds_read_b64_tr_b16 v[204:205], v23 offset:14496
  ds_read_b64_tr_b16 v[206:207], v23 offset:18080
  s_waitcnt lgkmcnt(4)
  v_mfma_f32_16x16x32_bf16 v[192:195], v[208:211], v[104:107], v[192:195]
  v_mfma_f32_16x16x32_bf16 v[196:199], v[208:211], v[108:111], v[196:199]
  ds_read_b64_tr_b16 v[208:209], v23 offset:14528
  ds_read_b64_tr_b16 v[210:211], v23 offset:18112
  s_waitcnt lgkmcnt(4)
  v_mfma_f32_16x16x32_bf16 v[176:179], v[200:203], v[112:115], v[176:179]
  v_mfma_f32_16x16x32_bf16 v[180:183], v[200:203], v[116:119], v[180:183]
  ds_read_b64_tr_b16 v[200:201], v23 offset:21632
  ds_read_b64_tr_b16 v[202:203], v23 offset:25216
  s_waitcnt lgkmcnt(4)
  v_mfma_f32_16x16x32_bf16 v[184:187], v[204:207], v[112:115], v[184:187]
  v_mfma_f32_16x16x32_bf16 v[188:191], v[204:207], v[116:119], v[188:191]
  ds_read_b64_tr_b16 v[204:205], v23 offset:21664
  ds_read_b64_tr_b16 v[206:207], v23 offset:25248
  s_waitcnt lgkmcnt(4)
  v_mfma_f32_16x16x32_bf16 v[192:195], v[208:211], v[112:115], v[192:195]
  v_mfma_f32_16x16x32_bf16 v[196:199], v[208:211], v[116:119], v[196:199]
  ds_read_b64_tr_b16 v[208:209], v23 offset:21696
  ds_read_b64_tr_b16 v[210:211], v23 offset:25280
  s_waitcnt vmcnt(0)
  s_lshl_b32 s71, s68, 9
  s_lshl_b32 s72, s70, 7
  s_add_u32 s71, s71, s72
  s_lshl_b32 s72, s69, 3
  s_add_u32 s71, s71, s72
  s_add_u32 s71, s71, 16801792
  v_mov_b32 v2, s4
  v_mov_b32 v3, s5
  v_mov_b32 v4, 0
  s_mov_b64 exec, 1
  buffer_store_dwordx2 v[2:3], v4, s[60:63], s71 offen sc1
  s_mov_b64 exec, -1
  s_waitcnt lgkmcnt(4)
  v_mfma_f32_16x16x32_bf16 v[176:179], v[200:203], v[120:123], v[176:179]
  v_mfma_f32_16x16x32_bf16 v[180:183], v[200:203], v[124:127], v[180:183]
  ds_read_b64_tr_b16 v[200:201], v23 offset:28800
  ds_read_b64_tr_b16 v[202:203], v23 offset:32384
  s_waitcnt lgkmcnt(4)
  v_mfma_f32_16x16x32_bf16 v[184:187], v[204:207], v[120:123], v[184:187]
  v_mfma_f32_16x16x32_bf16 v[188:191], v[204:207], v[124:127], v[188:191]
  ds_read_b64_tr_b16 v[204:205], v23 offset:28832
  ds_read_b64_tr_b16 v[206:207], v23 offset:32416
  s_waitcnt lgkmcnt(4)
  v_mfma_f32_16x16x32_bf16 v[192:195], v[208:211], v[120:123], v[192:195]
  v_mfma_f32_16x16x32_bf16 v[196:199], v[208:211], v[124:127], v[196:199]
  ds_read_b64_tr_b16 v[208:209], v23 offset:28864
  ds_read_b64_tr_b16 v[210:211], v23 offset:32448
  s_waitcnt lgkmcnt(4)
  v_mfma_f32_16x16x32_bf16 v[176:179], v[200:203], v[128:131], v[176:179]
  v_mfma_f32_16x16x32_bf16 v[180:183], v[200:203], v[132:135], v[180:183]
  ds_read_b64_tr_b16 v[200:201], v23 offset:35968
  ds_read_b64_tr_b16 v[202:203], v23 offset:39552
  s_waitcnt lgkmcnt(4)
  v_mfma_f32_16x16x32_bf16 v[184:187], v[204:207], v[128:131], v[184:187]
  v_mfma_f32_16x16x32_bf16 v[188:191], v[204:207], v[132:135], v[188:191]
  ds_read_b64_tr_b16 v[204:205], v23 offset:36000
  ds_read_b64_tr_b16 v[206:207], v23 offset:39584
  s_waitcnt lgkmcnt(4)
  v_mfma_f32_16x16x32_bf16 v[192:195], v[208:211], v[128:131], v[192:195]
  v_mfma_f32_16x16x32_bf16 v[196:199], v[208:211], v[132:135], v[196:199]
  ds_read_b64_tr_b16 v[208:209], v23 offset:36032
  ds_read_b64_tr_b16 v[210:211], v23 offset:39616
  s_waitcnt lgkmcnt(4)
  v_mfma_f32_16x16x32_bf16 v[176:179], v[200:203], v[136:139], v[176:179]
  v_mfma_f32_16x16x32_bf16 v[180:183], v[200:203], v[140:143], v[180:183]
  s_waitcnt lgkmcnt(2)
  v_mfma_f32_16x16x32_bf16 v[184:187], v[204:207], v[136:139], v[184:187]
  v_mfma_f32_16x16x32_bf16 v[188:191], v[204:207], v[140:143], v[188:191]
  s_waitcnt lgkmcnt(0)
  v_mfma_f32_16x16x32_bf16 v[192:195], v[208:211], v[136:139], v[192:195]
  v_mfma_f32_16x16x32_bf16 v[196:199], v[208:211], v[140:143], v[196:199]
  v_mfma_f32_16x16x32_bf16 v[176:179], v[248:251], v[220:223], v[176:179]
  v_mfma_f32_16x16x32_bf16 v[180:183], v[248:251], v[224:227], v[180:183]
  v_mfma_f32_16x16x32_bf16 v[184:187], v[250:253], v[220:223], v[184:187]
  v_mfma_f32_16x16x32_bf16 v[188:191], v[250:253], v[224:227], v[188:191]
  v_mfma_f32_16x16x32_bf16 v[192:195], v[250:253], v[24:27], v[192:195]
  v_mfma_f32_16x16x32_bf16 v[196:199], v[250:253], v[28:31], v[196:199]
  v_accvgpr_read_b32 v5, a240
  v_accvgpr_read_b32 v6, a241
  v_accvgpr_read_b32 v7, a242
  v_accvgpr_read_b32 v8, a243
  v_fma_f32 v176, v176, v16, v5
  v_fma_f32 v177, v177, v16, v6
  v_fma_f32 v178, v178, v16, v7
  v_fma_f32 v179, v179, v16, v8
  v_max_f32 v176, 0, v176
  v_max_f32 v177, 0, v177
  v_max_f32 v178, 0, v178
  v_max_f32 v179, 0, v179
  v_mul_f32 v176, v176, v176
  v_mul_f32 v177, v177, v177
  v_mul_f32 v178, v178, v178
  v_mul_f32 v179, v179, v179
  v_cvt_pk_bf16_f32 v176, v176, v177
  v_cvt_pk_bf16_f32 v177, v178, v179
  v_accvgpr_read_b32 v5, a244
  v_accvgpr_read_b32 v6, a245
  v_accvgpr_read_b32 v7, a246
  v_accvgpr_read_b32 v8, a247
  v_fma_f32 v184, v184, v16, v5
  v_fma_f32 v185, v185, v16, v6
  v_fma_f32 v186, v186, v16, v7
  v_fma_f32 v187, v187, v16, v8
  v_max_f32 v184, 0, v184
  v_max_f32 v185, 0, v185
  v_max_f32 v186, 0, v186
  v_max_f32 v187, 0, v187
  v_mul_f32 v184, v184, v184
  v_mul_f32 v185, v185, v185
  v_mul_f32 v186, v186, v186
  v_mul_f32 v187, v187, v187
  v_cvt_pk_bf16_f32 v178, v184, v185
  v_cvt_pk_bf16_f32 v179, v186, v187
  s_lshl_b32 s71, s88, 10
  s_add_u32 s71, s71, 4096
  s_add_u32 s71, s71, s81
  buffer_store_dwordx4 v[176:179], v238, s[60:63], s71 offen sc1
  v_accvgpr_read_b32 v5, a240
  v_accvgpr_read_b32 v6, a241
  v_accvgpr_read_b32 v7, a242
  v_accvgpr_read_b32 v8, a243
  v_fma_f32 v180, v180, v17, v5
  v_fma_f32 v181, v181, v17, v6
  v_fma_f32 v182, v182, v17, v7
  v_fma_f32 v183, v183, v17, v8
  v_max_f32 v180, 0, v180
  v_max_f32 v181, 0, v181
  v_max_f32 v182, 0, v182
  v_max_f32 v183, 0, v183
  v_mul_f32 v180, v180, v180
  v_mul_f32 v181, v181, v181
  v_mul_f32 v182, v182, v182
  v_mul_f32 v183, v183, v183
  v_cvt_pk_bf16_f32 v180, v180, v181
  v_cvt_pk_bf16_f32 v181, v182, v183
  v_accvgpr_read_b32 v5, a244
  v_accvgpr_read_b32 v6, a245
  v_accvgpr_read_b32 v7, a246
  v_accvgpr_read_b32 v8, a247
  v_fma_f32 v188, v188, v17, v5
  v_fma_f32 v189, v189, v17, v6
  v_fma_f32 v190, v190, v17, v7
  v_fma_f32 v191, v191, v17, v8
  v_max_f32 v188, 0, v188
  v_max_f32 v189, 0, v189
  v_max_f32 v190, 0, v190
  v_max_f32 v191, 0, v191
  v_mul_f32 v188, v188, v188
  v_mul_f32 v189, v189, v189
  v_mul_f32 v190, v190, v190
  v_mul_f32 v191, v191, v191
  v_cvt_pk_bf16_f32 v182, v188, v189
  v_cvt_pk_bf16_f32 v183, v190, v191
  s_lshl_b32 s71, s88, 10
  s_add_u32 s71, s71, 61440
  s_add_u32 s71, s71, s81
  buffer_store_dwordx4 v[180:183], v238, s[60:63], s71 offen sc1
  v_accvgpr_read_b32 v5, a248
  v_accvgpr_read_b32 v6, a249
  v_accvgpr_read_b32 v7, a250
  v_accvgpr_read_b32 v8, a251
  v_fma_f32 v192, v192, v16, v5
  v_fma_f32 v193, v193, v16, v6
  v_fma_f32 v194, v194, v16, v7
  v_fma_f32 v195, v195, v16, v8
  v_max_f32 v192, 0, v192
  v_max_f32 v193, 0, v193
  v_max_f32 v194, 0, v194
  v_max_f32 v195, 0, v195
  v_mul_f32 v192, v192, v192
  v_mul_f32 v193, v193, v193
  v_mul_f32 v194, v194, v194
  v_mul_f32 v195, v195, v195
  v_cvt_pk_bf16_f32 v192, v192, v193
  v_cvt_pk_bf16_f32 v193, v194, v195
  s_lshl_b32 s71, s88, 3
  s_add_u32 s71, s71, 6144
  s_add_u32 s71, s71, s81
  buffer_store_dwordx2 v[192:193], v238, s[60:63], s71 offen sc1
  v_accvgpr_read_b32 v5, a248
  v_accvgpr_read_b32 v6, a249
  v_accvgpr_read_b32 v7, a250
  v_accvgpr_read_b32 v8, a251
  v_fma_f32 v196, v196, v17, v5
  v_fma_f32 v197, v197, v17, v6
  v_fma_f32 v198, v198, v17, v7
  v_fma_f32 v199, v199, v17, v8
  v_max_f32 v196, 0, v196
  v_max_f32 v197, 0, v197
  v_max_f32 v198, 0, v198
  v_max_f32 v199, 0, v199
  v_mul_f32 v196, v196, v196
  v_mul_f32 v197, v197, v197
  v_mul_f32 v198, v198, v198
  v_mul_f32 v199, v199, v199
  v_cvt_pk_bf16_f32 v196, v196, v197
  v_cvt_pk_bf16_f32 v197, v198, v199
  s_lshl_b32 s71, s88, 3
  s_add_u32 s71, s71, 63488
  s_add_u32 s71, s71, s81
  buffer_store_dwordx2 v[196:197], v238, s[60:63], s71 offen sc1
  s_cmp_ge_u32 s69, 14
  s_cbranch_scc1 Lidle_57
  s_lshl_b32 s77, s68, 3
  s_lshl_b32 s71, s93, 2
  s_add_u32 s77, s77, s71
  v_lshlrev_b32 v16, 3, v231
  buffer_load_dwordx2 v[212:213], v16, s[52:55], s91 offen offset:0
  buffer_load_dwordx2 v[214:215], v16, s[52:55], s91 offen offset:32
  buffer_load_dwordx2 v[216:217], v16, s[52:55], s91 offen offset:64
  buffer_load_dwordx2 v[218:219], v16, s[52:55], s91 offen offset:96
  s_add_u32 s71, s77, s70
  s_mul_i32 s71, s71, 14
  s_lshl_b32 s73, s92, 1
  s_add_u32 s71, s71, s73
  s_lshl_b32 s71, s71, 10
  s_add_u32 s71, s71, 2097152
  buffer_load_dwordx4 v[204:207], v238, s[60:63], s71 offen sc1
  buffer_load_dwordx4 v[208:211], v238, s[60:63], s71 offen offset:1024 sc1
  s_waitcnt vmcnt(6)
  s_lshl_b32 s71, s68, 9
  s_lshl_b32 s72, s70, 7
  s_add_u32 s71, s71, s72
  s_lshl_b32 s72, s69, 3
  s_add_u32 s71, s71, s72
  s_add_u32 s71, s71, 16809984
  v_mov_b32 v2, s4
  v_mov_b32 v3, s5
  v_mov_b32 v4, 0
  s_mov_b64 exec, 1
  buffer_store_dwordx2 v[2:3], v4, s[60:63], s71 offen sc1
  s_mov_b64 exec, -1
  s_mul_i32 s80, s77, 57344
  s_mul_i32 s73, s70, 14336
  s_add_u32 s80, s80, s73
  s_add_u32 s80, s80, 4718592
  s_lshl_b32 s71, s68, 9
  s_lshl_b32 s72, s93, 8
  s_add_u32 s71, s71, s72
  s_lshl_b32 s72, s70, 5
  s_add_u32 s71, s71, s72
  s_add_u32 s71, s71, 16801792
  v_and_b32 v4, 3, v1
  v_lshlrev_b32 v4, 3, v4
  v_bfe_u32 v3, v1, 2, 1
  v_lshl_add_u32 v4, v3, 7, v4
  v_add_u32 v4, s71, v4
  s_bfm_b64 exec, 8, 0
  s_mov_b32 s72, 0
Lpoll_58:
  buffer_load_dwordx2 v[2:3], v4, s[60:63], 0 offen sc1
  s_add_u32 s72, s72, 1
  s_cmp_gt_u32 s72, 0x40000
  s_cbranch_scc1 Lend
  s_waitcnt vmcnt(0)
  v_cmp_ne_u32 vcc, s4, v2
  v_cmp_ne_u32 s[96:97], s5, v3
  s_nop 2
  s_or_b64 vcc, vcc, s[96:97]
  s_cbranch_vccnz Lpoll_58
  s_mov_b64 exec, -1
  s_add_u32 s71, s80, 0
  buffer_load_dwordx4 v[96:99], v238, s[60:63], s71 offen sc1
  s_add_u32 s71, s80, 57344
  buffer_load_dwordx4 v[100:103], v238, s[60:63], s71 offen sc1
  s_add_u32 s71, s80, 114688
  buffer_load_dwordx4 v[104:107], v238, s[60:63], s71 offen sc1
  s_add_u32 s71, s80, 172032
  buffer_load_dwordx4 v[108:111], v238, s[60:63], s71 offen sc1
  s_add_u32 s71, s80, 1024
  buffer_load_dwordx4 v[112:115], v238, s[60:63], s71 offen sc1
  s_add_u32 s71, s80, 58368
  buffer_load_dwordx4 v[116:119], v238, s[60:63], s71 offen sc1
  s_add_u32 s71, s80, 115712
  buffer_load_dwordx4 v[120:123], v238, s[60:63], s71 offen sc1
  s_add_u32 s71, s80, 173056
  buffer_load_dwordx4 v[124:127], v238, s[60:63], s71 offen sc1
  s_add_u32 s71, s80, 2048
  buffer_load_dwordx4 v[128:131], v238, s[60:63], s71 offen sc1
  s_add_u32 s71, s80, 59392
  buffer_load_dwordx4 v[132:135], v238, s[60:63], s71 offen sc1
  s_add_u32 s71, s80, 116736
  buffer_load_dwordx4 v[136:139], v238, s[60:63], s71 offen sc1
  s_add_u32 s71, s80, 174080
  buffer_load_dwordx4 v[140:143], v238, s[60:63], s71 offen sc1
  v_mov_b32 v5, v238
  s_sub_u32 s71, s70, 1
  s_and_b32 s71, s71, 3
  s_lshl_b32 s71, s71, 12
  s_add_u32 s75, s71, 0
  s_sub_u32 s71, s70, 2
  s_and_b32 s71, s71, 3
  s_lshl_b32 s71, s71, 12
  s_add_u32 s76, s71, 12288
  s_sub_u32 s71, s70, 3
  s_and_b32 s71, s71, 3
  s_lshl_b32 s71, s71, 12
  s_add_u32 s78, s71, 24576
  s_sub_u32 s71, s70, 4
  s_and_b32 s71, s71, 3
  s_lshl_b32 s71, s71, 12
  s_add_u32 s79, s71, 36864
  s_waitcnt vmcnt(11)
  v_mfma_f32_16x16x32_bf16 v[32:35], a[0:3], v[96:99], 0
  v_mfma_f32_16x16x32_bf16 v[36:39], a[4:7], v[96:99], 0
  v_mfma_f32_16x16x32_bf16 v[40:43], a[8:11], v[96:99], 0
  v_mfma_f32_16x16x32_bf16 v[44:47], a[12:15], v[96:99], 0
  s_add_u32 s71, s80, 3072
  buffer_load_dwordx4 v[96:99], v238, s[60:63], s71 offen sc1
  s_waitcnt vmcnt(11)
  v_mfma_f32_16x16x32_bf16 v[48:51], a[0:3], v[100:103], 0
  v_mfma_f32_16x16x32_bf16 v[52:55], a[4:7], v[100:103], 0
  v_mfma_f32_16x16x32_bf16 v[56:59], a[8:11], v[100:103], 0
  v_mfma_f32_16x16x32_bf16 v[60:63], a[12:15], v[100:103], 0
  s_add_u32 s71, s80, 60416
  buffer_load_dwordx4 v[100:103], v238, s[60:63], s71 offen sc1
  s_waitcnt vmcnt(11)
  v_mfma_f32_16x16x32_bf16 v[64:67], a[0:3], v[104:107], 0
  v_mfma_f32_16x16x32_bf16 v[68:71], a[4:7], v[104:107], 0
  v_mfma_f32_16x16x32_bf16 v[72:75], a[8:11], v[104:107], 0
  v_mfma_f32_16x16x32_bf16 v[76:79], a[12:15], v[104:107], 0
  s_add_u32 s71, s80, 117760
  buffer_load_dwordx4 v[104:107], v238, s[60:63], s71 offen sc1
  s_waitcnt vmcnt(11)
  v_mfma_f32_16x16x32_bf16 v[80:83], a[0:3], v[108:111], 0
  v_mfma_f32_16x16x32_bf16 v[84:87], a[4:7], v[108:111], 0
  v_mfma_f32_16x16x32_bf16 v[88:91], a[8:11], v[108:111], 0
  v_mfma_f32_16x16x32_bf16 v[92:95], a[12:15], v[108:111], 0
  s_add_u32 s71, s80, 175104
  buffer_load_dwordx4 v[108:111], v238, s[60:63], s71 offen sc1
  s_waitcnt vmcnt(11)
  v_mfma_f32_16x16x32_bf16 v[32:35], a[16:19], v[112:115], v[32:35]
  v_mfma_f32_16x16x32_bf16 v[36:39], a[20:23], v[112:115], v[36:39]
  v_mfma_f32_16x16x32_bf16 v[40:43], a[24:27], v[112:115], v[40:43]
  v_mfma_f32_16x16x32_bf16 v[44:47], a[28:31], v[112:115], v[44:47]
  s_add_u32 s71, s80, 7168
  buffer_load_dwordx4 v[112:115], v238, s[60:63], s71 offen sc1
  s_waitcnt vmcnt(11)
  v_mfma_f32_16x16x32_bf16 v[48:51], a[16:19], v[116:119], v[48:51]
  v_mfma_f32_16x16x32_bf16 v[52:55], a[20:23], v[116:119], v[52:55]
  v_mfma_f32_16x16x32_bf16 v[56:59], a[24:27], v[116:119], v[56:59]
  v_mfma_f32_16x16x32_bf16 v[60:63], a[28:31], v[116:119], v[60:63]
  s_add_u32 s71, s80, 64512
  buffer_load_dwordx4 v[116:119], v238, s[60:63], s71 offen sc1
  s_waitcnt vmcnt(11)
  v_mfma_f32_16x16x32_bf16 v[64:67], a[16:19], v[120:123], v[64:67]
  v_mfma_f32_16x16x32_bf16 v[68:71], a[20:23], v[120:123], v[68:71]
  v_mfma_f32_16x16x32_bf16 v[72:75], a[24:27], v[120:123], v[72:75]
  v_mfma_f32_16x16x32_bf16 v[76:79], a[28:31], v[120:123], v[76:79]
  s_add_u32 s71, s80, 121856
  buffer_load_dwordx4 v[120:123], v238, s[60:63], s71 offen sc1
  s_waitcnt vmcnt(11)
  v_mfma_f32_16x16x32_bf16 v[80:83], a[16:19], v[124:127], v[80:83]
  v_mfma_f32_16x16x32_bf16 v[84:87], a[20:23], v[124:127], v[84:87]
  v_mfma_f32_16x16x32_bf16 v[88:91], a[24:27], v[124:127], v[88:91]
  v_mfma_f32_16x16x32_bf16 v[92:95], a[28:31], v[124:127], v[92:95]
  s_add_u32 s71, s80, 179200
  buffer_load_dwordx4 v[124:127], v238, s[60:63], s71 offen sc1
  s_waitcnt vmcnt(11)
  v_mfma_f32_16x16x32_bf16 v[32:35], a[32:35], v[128:131], v[32:35]
  v_mfma_f32_16x16x32_bf16 v[36:39], a[36:39], v[128:131], v[36:39]
  v_mfma_f32_16x16x32_bf16 v[40:43], a[40:43], v[128:131], v[40:43]
  v_mfma_f32_16x16x32_bf16 v[44:47], a[44:47], v[128:131], v[44:47]
  s_add_u32 s71, s80, 8192
  buffer_load_dwordx4 v[128:131], v238, s[60:63], s71 offen sc1
  s_lshl_b32 s71, s68, 9
  s_lshl_b32 s72, s93, 8
  s_add_u32 s71, s71, s72
  s_lshl_b32 s72, s70, 5
  s_add_u32 s71, s71, s72
  s_add_u32 s71, s71, 16809984
  v_and_b32 v4, 3, v1
  v_lshlrev_b32 v4, 3, v4
  v_bfe_u32 v3, v1, 2, 1
  v_lshl_add_u32 v4, v3, 7, v4
  v_add_u32 v4, s71, v4
  v_mov_b32 v222, v4
  s_mov_b64 exec, 0xff
  buffer_load_dwordx2 v[220:221], v222, s[60:63], 0 offen sc1
  s_mov_b64 exec, -1
  s_waitcnt vmcnt(12)
  v_mfma_f32_16x16x32_bf16 v[48:51], a[32:35], v[132:135], v[48:51]
  v_mfma_f32_16x16x32_bf16 v[52:55], a[36:39], v[132:135], v[52:55]
  v_mfma_f32_16x16x32_bf16 v[56:59], a[40:43], v[132:135], v[56:59]
  v_mfma_f32_16x16x32_bf16 v[60:63], a[44:47], v[132:135], v[60:63]
  s_add_u32 s71, s80, 65536
  buffer_load_dwordx4 v[132:135], v238, s[60:63], s71 offen sc1
  s_waitcnt vmcnt(12)
  v_mfma_f32_16x16x32_bf16 v[64:67], a[32:35], v[136:139], v[64:67]
  v_mfma_f32_16x16x32_bf16 v[68:71], a[36:39], v[136:139], v[68:71]
  v_mfma_f32_16x16x32_bf16 v[72:75], a[40:43], v[136:139], v[72:75]
  v_mfma_f32_16x16x32_bf16 v[76:79], a[44:47], v[136:139], v[76:79]
  s_add_u32 s71, s80, 122880
  buffer_load_dwordx4 v[136:139], v238, s[60:63], s71 offen sc1
  s_waitcnt vmcnt(12)
  v_mfma_f32_16x16x32_bf16 v[80:83], a[32:35], v[140:143], v[80:83]
  v_mfma_f32_16x16x32_bf16 v[84:87], a[36:39], v[140:143], v[84:87]
  v_mfma_f32_16x16x32_bf16 v[88:91], a[40:43], v[140:143], v[88:91]
  v_mfma_f32_16x16x32_bf16 v[92:95], a[44:47], v[140:143], v[92:95]
  s_add_u32 s71, s80, 180224
  buffer_load_dwordx4 v[140:143], v238, s[60:63], s71 offen sc1
  s_waitcnt vmcnt(12)
  v_mfma_f32_16x16x32_bf16 v[32:35], a[48:51], v[96:99], v[32:35]
  v_mfma_f32_16x16x32_bf16 v[36:39], a[52:55], v[96:99], v[36:39]
  v_mfma_f32_16x16x32_bf16 v[40:43], a[56:59], v[96:99], v[40:43]
  v_mfma_f32_16x16x32_bf16 v[44:47], a[60:63], v[96:99], v[44:47]
  s_add_u32 s71, s80, 9216
  buffer_load_dwordx4 v[96:99], v238, s[60:63], s71 offen sc1
  s_waitcnt vmcnt(12)
  v_mfma_f32_16x16x32_bf16 v[48:51], a[48:51], v[100:103], v[48:51]
  v_mfma_f32_16x16x32_bf16 v[52:55], a[52:55], v[100:103], v[52:55]
  v_mfma_f32_16x16x32_bf16 v[56:59], a[56:59], v[100:103], v[56:59]
  v_mfma_f32_16x16x32_bf16 v[60:63], a[60:63], v[100:103], v[60:63]
  s_add_u32 s71, s80, 66560
  buffer_load_dwordx4 v[100:103], v238, s[60:63], s71 offen sc1
  s_waitcnt vmcnt(12)
  v_mfma_f32_16x16x32_bf16 v[64:67], a[48:51], v[104:107], v[64:67]
  v_mfma_f32_16x16x32_bf16 v[68:71], a[52:55], v[104:107], v[68:71]
  v_mfma_f32_16x16x32_bf16 v[72:75], a[56:59], v[104:107], v[72:75]
  v_mfma_f32_16x16x32_bf16 v[76:79], a[60:63], v[104:107], v[76:79]
  s_add_u32 s71, s80, 123904
  buffer_load_dwordx4 v[104:107], v238, s[60:63], s71 offen sc1
  s_waitcnt vmcnt(12)
  v_mfma_f32_16x16x32_bf16 v[80:83], a[48:51], v[108:111], v[80:83]
  v_mfma_f32_16x16x32_bf16 v[84:87], a[52:55], v[108:111], v[84:87]
  v_mfma_f32_16x16x32_bf16 v[88:91], a[56:59], v[108:111], v[88:91]
  v_mfma_f32_16x16x32_bf16 v[92:95], a[60:63], v[108:111], v[92:95]
  s_add_u32 s71, s80, 181248
  buffer_load_dwordx4 v[108:111], v238, s[60:63], s71 offen sc1
  s_waitcnt vmcnt(12)
  v_mfma_f32_16x16x32_bf16 v[32:35], a[112:115], v[112:115], v[32:35]
  v_mfma_f32_16x16x32_bf16 v[36:39], a[116:119], v[112:115], v[36:39]
  v_mfma_f32_16x16x32_bf16 v[40:43], a[120:123], v[112:115], v[40:43]
  v_mfma_f32_16x16x32_bf16 v[44:47], a[124:127], v[112:115], v[44:47]
  s_add_u32 s71, s80, 10240
  buffer_load_dwordx4 v[112:115], v238, s[60:63], s71 offen sc1
  s_waitcnt vmcnt(12)
  v_mfma_f32_16x16x32_bf16 v[48:51], a[112:115], v[116:119], v[48:51]
  v_mfma_f32_16x16x32_bf16 v[52:55], a[116:119], v[116:119], v[52:55]
  v_mfma_f32_16x16x32_bf16 v[56:59], a[120:123], v[116:119], v[56:59]
  v_mfma_f32_16x16x32_bf16 v[60:63], a[124:127], v[116:119], v[60:63]
  s_add_u32 s71, s80, 67584
  buffer_load_dwordx4 v[116:119], v238, s[60:63], s71 offen sc1
  s_waitcnt vmcnt(12)
  v_mfma_f32_16x16x32_bf16 v[64:67], a[112:115], v[120:123], v[64:67]
  v_mfma_f32_16x16x32_bf16 v[68:71], a[116:119], v[120:123], v[68:71]
  v_mfma_f32_16x16x32_bf16 v[72:75], a[120:123], v[120:123], v[72:75]
  v_mfma_f32_16x16x32_bf16 v[76:79], a[124:127], v[120:123], v[76:79]
  s_add_u32 s71, s80, 124928
  buffer_load_dwordx4 v[120:123], v238, s[60:63], s71 offen sc1
  s_waitcnt vmcnt(12)
  v_mfma_f32_16x16x32_bf16 v[80:83], a[112:115], v[124:127], v[80:83]
  v_mfma_f32_16x16x32_bf16 v[84:87], a[116:119], v[124:127], v[84:87]
  v_mfma_f32_16x16x32_bf16 v[88:91], a[120:123], v[124:127], v[88:91]
  v_mfma_f32_16x16x32_bf16 v[92:95], a[124:127], v[124:127], v[92:95]
  s_add_u32 s71, s80, 182272
  buffer_load_dwordx4 v[124:127], v238, s[60:63], s71 offen sc1
  s_waitcnt vmcnt(12)
  v_mfma_f32_16x16x32_bf16 v[32:35], a[128:131], v[128:131], v[32:35]
  v_mfma_f32_16x16x32_bf16 v[36:39], a[132:135], v[128:131], v[36:39]
  v_mfma_f32_16x16x32_bf16 v[40:43], a[136:139], v[128:131], v[40:43]
  v_mfma_f32_16x16x32_bf16 v[44:47], a[140:143], v[128:131], v[44:47]
  s_waitcnt vmcnt(11)
  v_cmp_ne_u32 vcc, s4, v220
  v_cmp_ne_u32 s[96:97], s5, v221
  s_nop 2
  s_or_b64 vcc, vcc, s[96:97]
  s_and_b64 vcc, vcc, 0xff
  s_cbranch_vccz Ldok_60
  s_lshl_b32 s71, s68, 9
  s_lshl_b32 s72, s93, 8
  s_add_u32 s71, s71, s72
  s_lshl_b32 s72, s70, 5
  s_add_u32 s71, s71, s72
  s_add_u32 s71, s71, 16809984
  v_and_b32 v4, 3, v1
  v_lshlrev_b32 v4, 3, v4
  v_bfe_u32 v3, v1, 2, 1
  v_lshl_add_u32 v4, v3, 7, v4
  v_add_u32 v4, s71, v4
  s_bfm_b64 exec, 8, 0
  s_mov_b32 s72, 0
Lpoll_61:
  buffer_load_dwordx2 v[2:3], v4, s[60:63], 0 offen sc1
  s_add_u32 s72, s72, 1
  s_cmp_gt_u32 s72, 0x40000
  s_cbranch_scc1 Lend
  s_waitcnt vmcnt(0)
  v_cmp_ne_u32 vcc, s4, v2
  v_cmp_ne_u32 s[96:97], s5, v3
  s_nop 2
  s_or_b64 vcc, vcc, s[96:97]
  s_cbranch_vccnz Lpoll_61
  s_mov_b64 exec, -1
Ldok_60:
  s_add_u32 s71, s80, 4096
  buffer_load_dwordx4 v[128:131], v238, s[60:63], s71 offen sc1
  s_waitcnt vmcnt(11)
  v_mfma_f32_16x16x32_bf16 v[48:51], a[128:131], v[132:135], v[48:51]
  v_mfma_f32_16x16x32_bf16 v[52:55], a[132:135], v[132:135], v[52:55]
  v_mfma_f32_16x16x32_bf16 v[56:59], a[136:139], v[132:135], v[56:59]
  v_mfma_f32_16x16x32_bf16 v[60:63], a[140:143], v[132:135], v[60:63]
  s_add_u32 s71, s80, 61440
  buffer_load_dwordx4 v[132:135], v238, s[60:63], s71 offen sc1
  s_waitcnt vmcnt(11)
  v_mfma_f32_16x16x32_bf16 v[64:67], a[128:131], v[136:139], v[64:67]
  v_mfma_f32_16x16x32_bf16 v[68:71], a[132:135], v[136:139], v[68:71]
  v_mfma_f32_16x16x32_bf16 v[72:75], a[136:139], v[136:139], v[72:75]
  v_mfma_f32_16x16x32_bf16 v[76:79], a[140:143], v[136:139], v[76:79]
  s_add_u32 s71, s80, 118784
  buffer_load_dwordx4 v[136:139], v238, s[60:63], s71 offen sc1
  s_waitcnt vmcnt(11)
  v_mfma_f32_16x16x32_bf16 v[80:83], a[128:131], v[140:143], v[80:83]
  v_mfma_f32_16x16x32_bf16 v[84:87], a[132:135], v[140:143], v[84:87]
  v_mfma_f32_16x16x32_bf16 v[88:91], a[136:139], v[140:143], v[88:91]
  v_mfma_f32_16x16x32_bf16 v[92:95], a[140:143], v[140:143], v[92:95]
  s_add_u32 s71, s80, 176128
  buffer_load_dwordx4 v[140:143], v238, s[60:63], s71 offen sc1
  s_waitcnt vmcnt(11)
  v_mfma_f32_16x16x32_bf16 v[32:35], a[144:147], v[96:99], v[32:35]
  v_mfma_f32_16x16x32_bf16 v[36:39], a[148:151], v[96:99], v[36:39]
  v_mfma_f32_16x16x32_bf16 v[40:43], a[152:155], v[96:99], v[40:43]
  v_mfma_f32_16x16x32_bf16 v[44:47], a[156:159], v[96:99], v[44:47]
  s_add_u32 s71, s80, 5120
  buffer_load_dwordx4 v[96:99], v238, s[60:63], s71 offen sc1
  s_waitcnt vmcnt(11)
  v_mfma_f32_16x16x32_bf16 v[48:51], a[144:147], v[100:103], v[48:51]
  v_mfma_f32_16x16x32_bf16 v[52:55], a[148:151], v[100:103], v[52:55]
  v_mfma_f32_16x16x32_bf16 v[56:59], a[152:155], v[100:103], v[56:59]
  v_mfma_f32_16x16x32_bf16 v[60:63], a[156:159], v[100:103], v[60:63]
  s_add_u32 s71, s80, 62464
  buffer_load_dwordx4 v[100:103], v238, s[60:63], s71 offen sc1
  s_waitcnt vmcnt(11)
  v_mfma_f32_16x16x32_bf16 v[64:67], a[144:147], v[104:107], v[64:67]
  v_mfma_f32_16x16x32_bf16 v[68:71], a[148:151], v[104:107], v[68:71]
  v_mfma_f32_16x16x32_bf16 v[72:75], a[152:155], v[104:107], v[72:75]
  v_mfma_f32_16x16x32_bf16 v[76:79], a[156:159], v[104:107], v[76:79]
  s_add_u32 s71, s80, 119808
  buffer_load_dwordx4 v[104:107], v238, s[60:63], s71 offen sc1
  s_waitcnt vmcnt(11)
  v_mfma_f32_16x16x32_bf16 v[80:83], a[144:147], v[108:111], v[80:83]
  v_mfma_f32_16x16x32_bf16 v[84:87], a[148:151], v[108:111], v[84:87]
  v_mfma_f32_16x16x32_bf16 v[88:91], a[152:155], v[108:111], v[88:91]
  v_mfma_f32_16x16x32_bf16 v[92:95], a[156:159], v[108:111], v[92:95]
  s_add_u32 s71, s80, 177152
  buffer_load_dwordx4 v[108:111], v238, s[60:63], s71 offen sc1
  s_waitcnt vmcnt(11)
  v_mfma_f32_16x16x32_bf16 v[32:35], a[160:163], v[112:115], v[32:35]
  v_mfma_f32_16x16x32_bf16 v[36:39], a[164:167], v[112:115], v[36:39]
  v_mfma_f32_16x16x32_bf16 v[40:43], a[168:171], v[112:115], v[40:43]
  v_mfma_f32_16x16x32_bf16 v[44:47], a[172:175], v[112:115], v[44:47]
  s_add_u32 s71, s80, 6144
  buffer_load_dwordx4 v[112:115], v238, s[60:63], s71 offen sc1
  s_waitcnt vmcnt(11)
  v_mfma_f32_16x16x32_bf16 v[48:51], a[160:163], v[116:119], v[48:51]
  v_mfma_f32_16x16x32_bf16 v[52:55], a[164:167], v[116:119], v[52:55]
  v_mfma_f32_16x16x32_bf16 v[56:59], a[168:171], v[116:119], v[56:59]
  v_mfma_f32_16x16x32_bf16 v[60:63], a[172:175], v[116:119], v[60:63]
  s_add_u32 s71, s80, 63488
  buffer_load_dwordx4 v[116:119], v238, s[60:63], s71 offen sc1
  s_waitcnt vmcnt(11)
  v_mfma_f32_16x16x32_bf16 v[64:67], a[160:163], v[120:123], v[64:67]
  v_mfma_f32_16x16x32_bf16 v[68:71], a[164:167], v[120:123], v[68:71]
  v_mfma_f32_16x16x32_bf16 v[72:75], a[168:171], v[120:123], v[72:75]
  v_mfma_f32_16x16x32_bf16 v[76:79], a[172:175], v[120:123], v[76:79]
  s_add_u32 s71, s80, 120832
  buffer_load_dwordx4 v[120:123], v238, s[60:63], s71 offen sc1
  s_waitcnt vmcnt(11)
  v_mfma_f32_16x16x32_bf16 v[80:83], a[160:163], v[124:127], v[80:83]
  v_mfma_f32_16x16x32_bf16 v[84:87], a[164:167], v[124:127], v[84:87]
  v_mfma_f32_16x16x32_bf16 v[88:91], a[168:171], v[124:127], v[88:91]
  v_mfma_f32_16x16x32_bf16 v[92:95], a[172:175], v[124:127], v[92:95]
  s_add_u32 s71, s80, 178176
  buffer_load_dwordx4 v[124:127], v238, s[60:63], s71 offen sc1
  s_waitcnt vmcnt(11)
  v_mfma_f32_16x16x32_bf16 v[32:35], a[64:67], v[128:131], v[32:35]
  v_mfma_f32_16x16x32_bf16 v[36:39], a[68:71], v[128:131], v[36:39]
  v_mfma_f32_16x16x32_bf16 v[40:43], a[72:75], v[128:131], v[40:43]
  v_mfma_f32_16x16x32_bf16 v[44:47], a[76:79], v[128:131], v[44:47]
  s_add_u32 s71, s80, 11264
  buffer_load_dwordx4 v[128:131], v238, s[60:63], s71 offen sc1
  s_waitcnt vmcnt(11)
  v_mfma_f32_16x16x32_bf16 v[48:51], a[64:67], v[132:135], v[48:51]
  v_mfma_f32_16x16x32_bf16 v[52:55], a[68:71], v[132:135], v[52:55]
  v_mfma_f32_16x16x32_bf16 v[56:59], a[72:75], v[132:135], v[56:59]
  v_mfma_f32_16x16x32_bf16 v[60:63], a[76:79], v[132:135], v[60:63]
  s_add_u32 s71, s80, 68608
  buffer_load_dwordx4 v[132:135], v238, s[60:63], s71 offen sc1
  s_waitcnt vmcnt(11)
  v_mfma_f32_16x16x32_bf16 v[64:67], a[64:67], v[136:139], v[64:67]
  v_mfma_f32_16x16x32_bf16 v[68:71], a[68:71], v[136:139], v[68:71]
  v_mfma_f32_16x16x32_bf16 v[72:75], a[72:75], v[136:139], v[72:75]
  v_mfma_f32_16x16x32_bf16 v[76:79], a[76:79], v[136:139], v[76:79]
  s_add_u32 s71, s80, 125952
  buffer_load_dwordx4 v[136:139], v238, s[60:63], s71 offen sc1
  s_waitcnt vmcnt(11)
  v_mfma_f32_16x16x32_bf16 v[80:83], a[64:67], v[140:143], v[80:83]
  v_mfma_f32_16x16x32_bf16 v[84:87], a[68:71], v[140:143], v[84:87]
  v_mfma_f32_16x16x32_bf16 v[88:91], a[72:75], v[140:143], v[88:91]
  v_mfma_f32_16x16x32_bf16 v[92:95], a[76:79], v[140:143], v[92:95]
  s_add_u32 s71, s80, 183296
  buffer_load_dwordx4 v[140:143], v238, s[60:63], s71 offen sc1
  s_waitcnt vmcnt(11)
  v_mfma_f32_16x16x32_bf16 v[32:35], a[80:83], v[96:99], v[32:35]
  v_mfma_f32_16x16x32_bf16 v[36:39], a[84:87], v[96:99], v[36:39]
  v_mfma_f32_16x16x32_bf16 v[40:43], a[88:91], v[96:99], v[40:43]
  v_mfma_f32_16x16x32_bf16 v[44:47], a[92:95], v[96:99], v[44:47]
  s_add_u32 s71, s80, 12288
  buffer_load_dwordx4 v[96:99], v238, s[60:63], s71 offen sc1
  s_waitcnt vmcnt(11)
  v_mfma_f32_16x16x32_bf16 v[48:51], a[80:83], v[100:103], v[48:51]
  v_mfma_f32_16x16x32_bf16 v[52:55], a[84:87], v[100:103], v[52:55]
  v_mfma_f32_16x16x32_bf16 v[56:59], a[88:91], v[100:103], v[56:59]
  v_mfma_f32_16x16x32_bf16 v[60:63], a[92:95], v[100:103], v[60:63]
  s_add_u32 s71, s80, 69632
  buffer_load_dwordx4 v[100:103], v238, s[60:63], s71 offen sc1
  s_waitcnt vmcnt(11)
  v_mfma_f32_16x16x32_bf16 v[64:67], a[80:83], v[104:107], v[64:67]
  v_mfma_f32_16x16x32_bf16 v[68:71], a[84:87], v[104:107], v[68:71]
  v_mfma_f32_16x16x32_bf16 v[72:75], a[88:91], v[104:107], v[72:75]
  v_mfma_f32_16x16x32_bf16 v[76:79], a[92:95], v[104:107], v[76:79]
  s_add_u32 s71, s80, 126976
  buffer_load_dwordx4 v[104:107], v238, s[60:63], s71 offen sc1
  s_waitcnt vmcnt(11)
  v_mfma_f32_16x16x32_bf16 v[80:83], a[80:83], v[108:111], v[80:83]
  v_mfma_f32_16x16x32_bf16 v[84:87], a[84:87], v[108:111], v[84:87]
  v_mfma_f32_16x16x32_bf16 v[88:91], a[88:91], v[108:111], v[88:91]
  v_mfma_f32_16x16x32_bf16 v[92:95], a[92:95], v[108:111], v[92:95]
  s_add_u32 s71, s80, 184320
  buffer_load_dwordx4 v[108:111], v238, s[60:63], s71 offen sc1
  s_waitcnt vmcnt(11)
  v_mfma_f32_16x16x32_bf16 v[32:35], a[96:99], v[112:115], v[32:35]
  v_mfma_f32_16x16x32_bf16 v[36:39], a[100:103], v[112:115], v[36:39]
  v_mfma_f32_16x16x32_bf16 v[40:43], a[104:107], v[112:115], v[40:43]
  v_mfma_f32_16x16x32_bf16 v[44:47], a[108:111], v[112:115], v[44:47]
  s_add_u32 s71, s80, 13312
  buffer_load_dwordx4 v[112:115], v238, s[60:63], s71 offen sc1
  s_waitcnt vmcnt(11)
  v_mfma_f32_16x16x32_bf16 v[48:51], a[96:99], v[116:119], v[48:51]
  v_mfma_f32_16x16x32_bf16 v[52:55], a[100:103], v[116:119], v[52:55]
  v_mfma_f32_16x16x32_bf16 v[56:59], a[104:107], v[116:119], v[56:59]
  v_mfma_f32_16x16x32_bf16 v[60:63], a[108:111], v[116:119], v[60:63]
  s_add_u32 s71, s80, 70656
  buffer_load_dwordx4 v[116:119], v238, s[60:63], s71 offen sc1
  s_waitcnt vmcnt(11)
  v_mfma_f32_16x16x32_bf16 v[64:67], a[96:99], v[120:123], v[64:67]
  v_mfma_f32_16x16x32_bf16 v[68:71], a[100:103], v[120:123], v[68:71]
  v_mfma_f32_16x16x32_bf16 v[72:75], a[104:107], v[120:123], v[72:75]
  v_mfma_f32_16x16x32_bf16 v[76:79], a[108:111], v[120:123], v[76:79]
  s_add_u32 s71, s80, 128000
  buffer_load_dwordx4 v[120:123], v238, s[60:63], s71 offen sc1
  s_waitcnt vmcnt(11)
  v_mfma_f32_16x16x32_bf16 v[80:83], a[96:99], v[124:127], v[80:83]
  v_mfma_f32_16x16x32_bf16 v[84:87], a[100:103], v[124:127], v[84:87]
  v_mfma_f32_16x16x32_bf16 v[88:91], a[104:107], v[124:127], v[88:91]
  v_mfma_f32_16x16x32_bf16 v[92:95], a[108:111], v[124:127], v[92:95]
  s_add_u32 s71, s80, 185344
  buffer_load_dwordx4 v[124:127], v238, s[60:63], s71 offen sc1
  s_waitcnt vmcnt(11)
  v_mfma_f32_16x16x32_bf16 v[32:35], a[176:179], v[128:131], v[32:35]
  v_mfma_f32_16x16x32_bf16 v[36:39], a[180:183], v[128:131], v[36:39]
  v_mfma_f32_16x16x32_bf16 v[40:43], a[184:187], v[128:131], v[40:43]
  v_mfma_f32_16x16x32_bf16 v[44:47], a[188:191], v[128:131], v[44:47]
  s_waitcnt vmcnt(10)
  v_mfma_f32_16x16x32_bf16 v[48:51], a[176:179], v[132:135], v[48:51]
  v_mfma_f32_16x16x32_bf16 v[52:55], a[180:183], v[132:135], v[52:55]
  v_mfma_f32_16x16x32_bf16 v[56:59], a[184:187], v[132:135], v[56:59]
  v_mfma_f32_16x16x32_bf16 v[60:63], a[188:191], v[132:135], v[60:63]
  s_waitcnt vmcnt(9)
  v_mfma_f32_16x16x32_bf16 v[64:67], a[176:179], v[136:139], v[64:67]
  v_mfma_f32_16x16x32_bf16 v[68:71], a[180:183], v[136:139], v[68:71]
  v_mfma_f32_16x16x32_bf16 v[72:75], a[184:187], v[136:139], v[72:75]
  v_mfma_f32_16x16x32_bf16 v[76:79], a[188:191], v[136:139], v[76:79]
  s_waitcnt vmcnt(8)
  v_mfma_f32_16x16x32_bf16 v[80:83], a[176:179], v[140:143], v[80:83]
  v_mfma_f32_16x16x32_bf16 v[84:87], a[180:183], v[140:143], v[84:87]
  v_mfma_f32_16x16x32_bf16 v[88:91], a[184:187], v[140:143], v[88:91]
  v_mfma_f32_16x16x32_bf16 v[92:95], a[188:191], v[140:143], v[92:95]
  s_waitcnt vmcnt(7)
  v_mfma_f32_16x16x32_bf16 v[32:35], a[192:195], v[96:99], v[32:35]
  v_mfma_f32_16x16x32_bf16 v[36:39], a[196:199], v[96:99], v[36:39]
  v_mfma_f32_16x16x32_bf16 v[40:43], a[200:203], v[96:99], v[40:43]
  v_mfma_f32_16x16x32_bf16 v[44:47], a[204:207], v[96:99], v[44:47]
  s_waitcnt vmcnt(6)
  v_mfma_f32_16x16x32_bf16 v[48:51], a[192:195], v[100:103], v[48:51]
  v_mfma_f32_16x16x32_bf16 v[52:55], a[196:199], v[100:103], v[52:55]
  v_mfma_f32_16x16x32_bf16 v[56:59], a[200:203], v[100:103], v[56:59]
  v_mfma_f32_16x16x32_bf16 v[60:63], a[204:207], v[100:103], v[60:63]
  s_waitcnt vmcnt(5)
  v_mfma_f32_16x16x32_bf16 v[64:67], a[192:195], v[104:107], v[64:67]
  v_mfma_f32_16x16x32_bf16 v[68:71], a[196:199], v[104:107], v[68:71]
  v_mfma_f32_16x16x32_bf16 v[72:75], a[200:203], v[104:107], v[72:75]
  v_mfma_f32_16x16x32_bf16 v[76:79], a[204:207], v[104:107], v[76:79]
  s_waitcnt vmcnt(4)
  v_mfma_f32_16x16x32_bf16 v[80:83], a[192:195], v[108:111], v[80:83]
  v_mfma_f32_16x16x32_bf16 v[84:87], a[196:199], v[108:111], v[84:87]
  v_mfma_f32_16x16x32_bf16 v[88:91], a[200:203], v[108:111], v[88:91]
  v_mfma_f32_16x16x32_bf16 v[92:95], a[204:207], v[108:111], v[92:95]
  s_waitcnt vmcnt(3)
  v_mfma_f32_16x16x32_bf16 v[32:35], a[208:211], v[112:115], v[32:35]
  v_mfma_f32_16x16x32_bf16 v[36:39], a[212:215], v[112:115], v[36:39]
  v_mfma_f32_16x16x32_bf16 v[40:43], a[216:219], v[112:115], v[40:43]
  v_mfma_f32_16x16x32_bf16 v[44:47], a[220:223], v[112:115], v[44:47]
  s_waitcnt vmcnt(2)
  v_mfma_f32_16x16x32_bf16 v[48:51], a[208:211], v[116:119], v[48:51]
  v_mfma_f32_16x16x32_bf16 v[52:55], a[212:215], v[116:119], v[52:55]
  v_mfma_f32_16x16x32_bf16 v[56:59], a[216:219], v[116:119], v[56:59]
  v_mfma_f32_16x16x32_bf16 v[60:63], a[220:223], v[116:119], v[60:63]
  s_cmp_eq_u32 s70, 0
  s_cbranch_scc1 Lrw_63
  v_add_u32 v6, s75, v238
  ds_write_b128 v6, v[32:35] offset:0
  ds_write_b128 v6, v[36:39] offset:1024
  ds_write_b128 v6, v[40:43] offset:2048
  ds_write_b128 v6, v[44:47] offset:3072
Lrw_63:
  s_waitcnt vmcnt(1)
  v_mfma_f32_16x16x32_bf16 v[64:67], a[208:211], v[120:123], v[64:67]
  v_mfma_f32_16x16x32_bf16 v[68:71], a[212:215], v[120:123], v[68:71]
  v_mfma_f32_16x16x32_bf16 v[72:75], a[216:219], v[120:123], v[72:75]
  v_mfma_f32_16x16x32_bf16 v[76:79], a[220:223], v[120:123], v[76:79]
  s_cmp_eq_u32 s70, 1
  s_cbranch_scc1 Lrw_64
  v_add_u32 v6, s76, v238
  ds_write_b128 v6, v[48:51] offset:0
  ds_write_b128 v6, v[52:55] offset:1024
  ds_write_b128 v6, v[56:59] offset:2048
  ds_write_b128 v6, v[60:63] offset:3072
Lrw_64:
  s_waitcnt vmcnt(0)
  v_mfma_f32_16x16x32_bf16 v[80:83], a[208:211], v[124:127], v[80:83]
  v_mfma_f32_16x16x32_bf16 v[84:87], a[212:215], v[124:127], v[84:87]
  v_mfma_f32_16x16x32_bf16 v[88:91], a[216:219], v[124:127], v[88:91]
  v_mfma_f32_16x16x32_bf16 v[92:95], a[220:223], v[124:127], v[92:95]
  s_cmp_eq_u32 s70, 2
  s_cbranch_scc1 Lrw_65
  v_add_u32 v6, s78, v238
  ds_write_b128 v6, v[64:67] offset:0
  ds_write_b128 v6, v[68:71] offset:1024
  ds_write_b128 v6, v[72:75] offset:2048
  ds_write_b128 v6, v[76:79] offset:3072
Lrw_65:
  s_cmp_eq_u32 s70, 3
  s_cbranch_scc1 Lrw_66
  v_add_u32 v6, s79, v238
  ds_write_b128 v6, v[80:83] offset:0
  ds_write_b128 v6, v[84:87] offset:1024
  ds_write_b128 v6, v[88:91] offset:2048
  ds_write_b128 v6, v[92:95] offset:3072
Lrw_66:
  s_waitcnt lgkmcnt(0)
  s_barrier
  s_mul_i32 s71, s70, 12288
  v_add_u32 v5, s71, v238
  ds_read_b128 v[112:115], v5 offset:0
  ds_read_b128 v[116:119], v5 offset:1024
  ds_read_b128 v[120:123], v5 offset:2048
  ds_read_b128 v[124:127], v5 offset:3072
  ds_read_b128 v[128:131], v5 offset:4096
  ds_read_b128 v[132:135], v5 offset:5120
  ds_read_b128 v[136:139], v5 offset:6144
  ds_read_b128 v[140:143], v5 offset:7168
  ds_read_b128 v[144:147], v5 offset:8192
  ds_read_b128 v[148:151], v5 offset:9216
  ds_read_b128 v[152:155], v5 offset:10240
  ds_read_b128 v[156:159], v5 offset:11264
  s_cmp_lg_u32 s70, 0
  s_cbranch_scc1 Lown_67
  v_mov_b32 v96, v32
  v_mov_b32 v97, v33
  v_mov_b32 v98, v34
  v_mov_b32 v99, v35
  v_mov_b32 v100, v36
  v_mov_b32 v101, v37
  v_mov_b32 v102, v38
  v_mov_b32 v103, v39
  v_mov_b32 v104, v40
  v_mov_b32 v105, v41
  v_mov_b32 v106, v42
  v_mov_b32 v107, v43
  v_mov_b32 v108, v44
  v_mov_b32 v109, v45
  v_mov_b32 v110, v46
  v_mov_b32 v111, v47
Lown_67:
  s_cmp_lg_u32 s70, 1
  s_cbranch_scc1 Lown_68
  v_mov_b32 v96, v48
  v_mov_b32 v97, v49
  v_mov_b32 v98, v50
  v_mov_b32 v99, v51
  v_mov_b32 v100, v52
  v_mov_b32 v101, v53
  v_mov_b32 v102, v54
  v_mov_b32 v103, v55
  v_mov_b32 v104, v56
  v_mov_b32 v105, v57
  v_mov_b32 v106, v58
  v_mov_b32 v107, v59
  v_mov_b32 v108, v60
  v_mov_b32 v109, v61
  v_mov_b32 v110, v62
  v_mov_b32 v111, v63
Lown_68:
  s_cmp_lg_u32 s70, 2
  s_cbranch_scc1 Lown_69
  v_mov_b32 v96, v64
  v_mov_b32 v97, v65
  v_mov_b32 v98, v66
  v_mov_b32 v99, v67
  v_mov_b32 v100, v68
  v_mov_b32 v101, v69
  v_mov_b32 v102, v70
  v_mov_b32 v103, v71
  v_mov_b32 v104, v72
  v_mov_b32 v105, v73
  v_mov_b32 v106, v74
  v_mov_b32 v107, v75
  v_mov_b32 v108, v76
  v_mov_b32 v109, v77
  v_mov_b32 v110, v78
  v_mov_b32 v111, v79
Lown_69:
  s_cmp_lg_u32 s70, 3
  s_cbranch_scc1 Lown_70
  v_mov_b32 v96, v80
  v_mov_b32 v97, v81
  v_mov_b32 v98, v82
  v_mov_b32 v99, v83
  v_mov_b32 v100, v84
  v_mov_b32 v101, v85
  v_mov_b32 v102, v86
  v_mov_b32 v103, v87
  v_mov_b32 v104, v88
  v_mov_b32 v105, v89
  v_mov_b32 v106, v90
  v_mov_b32 v107, v91
  v_mov_b32 v108, v92
  v_mov_b32 v109, v93
  v_mov_b32 v110, v94
  v_mov_b32 v111, v95
Lown_70:
  v_lshlrev_b32 v6, 16, v204
  v_and_b32 v7, 0xffff0000, v204
  v_add_f32 v96, v96, v6
  v_add_f32 v97, v97, v7
  v_lshlrev_b32 v6, 16, v212
  v_and_b32 v7, 0xffff0000, v212
  v_add_f32 v96, v96, v6
  v_add_f32 v97, v97, v7
  v_lshlrev_b32 v6, 16, v205
  v_and_b32 v7, 0xffff0000, v205
  v_add_f32 v98, v98, v6
  v_add_f32 v99, v99, v7
  v_lshlrev_b32 v6, 16, v213
  v_and_b32 v7, 0xffff0000, v213
  v_add_f32 v98, v98, v6
  v_add_f32 v99, v99, v7
  v_lshlrev_b32 v6, 16, v206
  v_and_b32 v7, 0xffff0000, v206
  v_add_f32 v100, v100, v6
  v_add_f32 v101, v101, v7
  v_lshlrev_b32 v6, 16, v214
  v_and_b32 v7, 0xffff0000, v214
  v_add_f32 v100, v100, v6
  v_add_f32 v101, v101, v7
  v_lshlrev_b32 v6, 16, v207
  v_and_b32 v7, 0xffff0000, v207
  v_add_f32 v102, v102, v6
  v_add_f32 v103, v103, v7
  v_lshlrev_b32 v6, 16, v215
  v_and_b32 v7, 0xffff0000, v215
  v_add_f32 v102, v102, v6
  v_add_f32 v103, v103, v7
  v_lshlrev_b32 v6, 16, v208
  v_and_b32 v7, 0xffff0000, v208
  v_add_f32 v104, v104, v6
  v_add_f32 v105, v105, v7
  v_lshlrev_b32 v6, 16, v216
  v_and_b32 v7, 0xffff0000, v216
  v_add_f32 v104, v104, v6
  v_add_f32 v105, v105, v7
  v_lshlrev_b32 v6, 16, v209
  v_and_b32 v7, 0xffff0000, v209
  v_add_f32 v106, v106, v6
  v_add_f32 v107, v107, v7
  v_lshlrev_b32 v6, 16, v217
  v_and_b32 v7, 0xffff0000, v217
  v_add_f32 v106, v106, v6
  v_add_f32 v107, v107, v7
  v_lshlrev_b32 v6, 16, v210
  v_and_b32 v7, 0xffff0000, v210
  v_add_f32 v108, v108, v6
  v_add_f32 v109, v109, v7
  v_lshlrev_b32 v6, 16, v218
  v_and_b32 v7, 0xffff0000, v218
  v_add_f32 v108, v108, v6
  v_add_f32 v109, v109, v7
  v_lshlrev_b32 v6, 16, v211
  v_and_b32 v7, 0xffff0000, v211
  v_add_f32 v110, v110, v6
  v_add_f32 v111, v111, v7
  v_lshlrev_b32 v6, 16, v219
  v_and_b32 v7, 0xffff0000, v219
  v_add_f32 v110, v110, v6
  v_add_f32 v111, v111, v7
  s_waitcnt lgkmcnt(0)
  v_add_f32 v112, v112, v128
  v_add_f32 v96, v96, v144
  v_add_f32 v113, v113, v129
  v_add_f32 v97, v97, v145
  v_add_f32 v114, v114, v130
  v_add_f32 v98, v98, v146
  v_add_f32 v115, v115, v131
  v_add_f32 v99, v99, v147
  v_add_f32 v116, v116, v132
  v_add_f32 v100, v100, v148
  v_add_f32 v117, v117, v133
  v_add_f32 v101, v101, v149
  v_add_f32 v118, v118, v134
  v_add_f32 v102, v102, v150
  v_add_f32 v119, v119, v135
  v_add_f32 v103, v103, v151
  v_add_f32 v120, v120, v136
  v_add_f32 v104, v104, v152
  v_add_f32 v121, v121, v137
  v_add_f32 v105, v105, v153
  v_add_f32 v122, v122, v138
  v_add_f32 v106, v106, v154
  v_add_f32 v123, v123, v139
  v_add_f32 v107, v107, v155
  v_add_f32 v124, v124, v140
  v_add_f32 v108, v108, v156
  v_add_f32 v125, v125, v141
  v_add_f32 v109, v109, v157
  v_add_f32 v126, v126, v142
  v_add_f32 v110, v110, v158
  v_add_f32 v127, v127, v143
  v_add_f32 v111, v111, v159
  v_add_f32 v96, v96, v112
  v_add_f32 v97, v97, v113
  v_add_f32 v98, v98, v114
  v_add_f32 v99, v99, v115
  v_add_f32 v100, v100, v116
  v_add_f32 v101, v101, v117
  v_add_f32 v102, v102, v118
  v_add_f32 v103, v103, v119
  v_add_f32 v104, v104, v120
  v_add_f32 v105, v105, v121
  v_add_f32 v106, v106, v122
  v_add_f32 v107, v107, v123
  v_add_f32 v108, v108, v124
  v_add_f32 v109, v109, v125
  v_add_f32 v110, v110, v126
  v_add_f32 v111, v111, v127
  v_cvt_pk_bf16_f32 v176, v96, v97
  v_cvt_pk_bf16_f32 v177, v98, v99
  v_cvt_pk_bf16_f32 v178, v100, v101
  v_cvt_pk_bf16_f32 v179, v102, v103
  v_cvt_pk_bf16_f32 v180, v104, v105
  v_cvt_pk_bf16_f32 v181, v106, v107
  v_cvt_pk_bf16_f32 v182, v108, v109
  v_cvt_pk_bf16_f32 v183, v110, v111
  v_permlane16_swap_b32 v176, v178
  v_permlane16_swap_b32 v177, v179
  v_permlane16_swap_b32 v180, v182
  v_permlane16_swap_b32 v181, v183
  s_add_u32 s71, s77, s70
  s_lshl_b32 s71, s71, 4
  v_and_b32 v6, 15, v1
  v_add_u32 v6, s71, v6
  v_mul_u32_u24 v6, 896, v6
  v_and_b32 v7, 1, v231
  v_lshl_add_u32 v6, v7, 5, v6
  v_lshrrev_b32 v7, 1, v231
  v_lshl_add_u32 v6, v7, 4, v6
  buffer_store_dwordx4 v[176:179], v6, s[56:59], s91 offen offset:0
  buffer_store_dwordx4 v[180:183], v6, s[56:59], s91 offen offset:64
  s_branch Lfin
Lidle_57:
  s_waitcnt vmcnt(0)
  s_lshl_b32 s71, s68, 9
  s_lshl_b32 s72, s70, 7
  s_add_u32 s71, s71, s72
  s_lshl_b32 s72, s69, 3
  s_add_u32 s71, s71, s72
  s_add_u32 s71, s71, 16809984
  v_mov_b32 v2, s4
  v_mov_b32 v3, s5
  v_mov_b32 v4, 0
  s_mov_b64 exec, 1
  buffer_store_dwordx2 v[2:3], v4, s[60:63], s71 offen sc1
  s_mov_b64 exec, -1
Lfin:
Lend:
  s_endpgm
.section .rodata,"a"
.p2align 6
.amdhsa_kernel sequential_preLN__sliding_block__dense_activation_squared_relu__prompt_kernel
  .amdhsa_next_free_vgpr 512
  .amdhsa_next_free_sgpr 100
  .amdhsa_accum_offset 256
  .amdhsa_group_segment_fixed_size 0
  .amdhsa_kernarg_size 88
  .amdhsa_user_sgpr_count 2
  .amdhsa_user_sgpr_kernarg_segment_ptr 1
  .amdhsa_system_sgpr_workgroup_id_x 1
  .amdhsa_float_denorm_mode_32 3
  .amdhsa_float_denorm_mode_16_64 3
.end_amdhsa_kernel
```
